```python
import torch

def _softmax(x, axis=-1):
    return torch.softmax(x, dim=axis)
def _gelu(x):
    return torch.nn.functional.gelu(x, approximate="tanh")
def _silu(x):
    return torch.nn.functional.silu(x)
def _sigmoid(x):
    return torch.sigmoid(x)
def _layernorm(x, axis=-1, eps=1e-5):
    m = x.mean(dim=axis, keepdim=True)
    v = x.var(dim=axis, keepdim=True, unbiased=False)
    return (x - m) / torch.sqrt(v + eps)
def _scatter_add(tgt, idx, src, axis=0):
    return tgt.clone().index_add_(axis, idx, src)
def _segment_sum(src, seg, n):
    out = torch.zeros((n,) + src.shape[1:], dtype=src.dtype)
    return out.index_add_(0, seg, src)
def _pad(x, pw):
    flat = tuple(v for pair in reversed(pw) for v in pair)
    return torch.nn.functional.pad(x, flat)

kernel_name = 'interleave_layers__sliding_block_cached__sliding_block_cached__decode'

def setup_inputs():

    _w = (lambda a: (lambda t: t.to(torch.bfloat16) if t.is_floating_point() else t)(torch.as_tensor(a)))
    def _A_setup():
        B, Sq, D = 2, 1, 512
        Hq, Hkv, Sk, Dh = 32, 32, 8192, 128
        assert Hq % Hkv == 0, (Hq, Hkv)
        return {
            "x": _w((lambda *s: torch.randn(*s, dtype=torch.bfloat16) * 0.1)(B, Sq, D)),
            "k_cache": _w((lambda *s: torch.randn(*s, dtype=torch.bfloat16) * 0.8)(B, Hkv, Sk, Dh)),
            "v_cache": _w((lambda *s: torch.randn(*s, dtype=torch.bfloat16) * 3.2)(B, Hkv, Sk, Dh)),
            "wq": _w((lambda *s: torch.randn(*s, dtype=torch.bfloat16) * 0.8)(D, Hq * Dh) * (D ** -0.5)),
            "wo": _w((lambda *s: torch.randn(*s, dtype=torch.bfloat16) * 3.2)(Hq * Dh, D) * ((Hq * Dh) ** -0.5)),
        }
    _A_in = _A_setup()

    def _B_setup():
        B, Sq, D = 2, 1, 512
        Hq, Hkv, Sk, Dh = 32, 32, 8192, 128
        assert Hq % Hkv == 0, (Hq, Hkv)
        return {
            "x": _w((lambda *s: torch.randn(*s, dtype=torch.bfloat16) * 0.1)(B, Sq, D)),
            "k_cache": _w((lambda *s: torch.randn(*s, dtype=torch.bfloat16) * 1.6)(B, Hkv, Sk, Dh)),
            "v_cache": _w((lambda *s: torch.randn(*s, dtype=torch.bfloat16) * 1.6)(B, Hkv, Sk, Dh)),
            "wq": _w((lambda *s: torch.randn(*s, dtype=torch.bfloat16) * 1.6)(D, Hq * Dh) * (D ** -0.5)),
            "wo": _w((lambda *s: torch.randn(*s, dtype=torch.bfloat16) * 1.6)(Hq * Dh, D) * ((Hq * Dh) ** -0.5)),
        }
    _B_in = _B_setup()

    return {
        "A_x": _A_in["x"],
        "A_k_cache": _A_in["k_cache"],
        "A_v_cache": _A_in["v_cache"],
        "A_wq": _A_in["wq"],
        "A_wo": _A_in["wo"],
        "B_x": _B_in["x"],
        "B_k_cache": _B_in["k_cache"],
        "B_v_cache": _B_in["v_cache"],
        "B_wq": _B_in["wq"],
        "B_wo": _B_in["wo"],
    }

def reference(A_x, A_k_cache, A_v_cache, A_wq, A_wo, B_x, B_k_cache, B_v_cache, B_wq, B_wo):
    def _A_ref(x, k_cache, v_cache, wq, wo):
        B, Sq, D = x.shape
        Hq, Dh = 32, 128
        Hkv, Sk = k_cache.shape[1], k_cache.shape[2]
        W = min(4096, max(256, Sk // 4))
        rep = Hq // Hkv
        q = (lambda x, *d: x.permute(*d))((x @ wq).reshape(B, Sq, Hq, Dh), 0, 2, 1, 3)
        k = (lambda x, n, axis: torch.repeat_interleave(x, n, dim=axis))(k_cache[:, :, Sk - W:, :], rep, axis=1)
        v = (lambda x, n, axis: torch.repeat_interleave(x, n, dim=axis))(v_cache[:, :, Sk - W:, :], rep, axis=1)
        scores = torch.einsum("bhqd,bhkd->bhqk", q, k) * (Dh ** -0.5)
        p = _softmax(scores, axis=-1)
        o = torch.einsum("bhqk,bhkd->bhqd", p, v)
        return (lambda x, *d: x.permute(*d))(o, 0, 2, 1, 3).reshape(B, Sq, Hq * Dh) @ wo

    def _B_ref(x, k_cache, v_cache, wq, wo):
        B, Sq, D = x.shape
        Hq, Dh = 32, 128
        Hkv, Sk = k_cache.shape[1], k_cache.shape[2]
        W = min(4096, max(256, Sk // 4))
        rep = Hq // Hkv
        q = (lambda x, *d: x.permute(*d))((x @ wq).reshape(B, Sq, Hq, Dh), 0, 2, 1, 3)
        k = (lambda x, n, axis: torch.repeat_interleave(x, n, dim=axis))(k_cache[:, :, Sk - W:, :], rep, axis=1)
        v = (lambda x, n, axis: torch.repeat_interleave(x, n, dim=axis))(v_cache[:, :, Sk - W:, :], rep, axis=1)
        scores = torch.einsum("bhqd,bhkd->bhqk", q, k) * (Dh ** -0.5)
        p = _softmax(scores, axis=-1)
        o = torch.einsum("bhqk,bhkd->bhqd", p, v)
        return (lambda x, *d: x.permute(*d))(o, 0, 2, 1, 3).reshape(B, Sq, Hq * Dh) @ wo

    x = A_x
    x = x + _A_ref(_layernorm(x, axis=-1), A_k_cache, A_v_cache, A_wq, A_wo)
    x = x + _B_ref(_layernorm(x, axis=-1), B_k_cache, B_v_cache, B_wq, B_wo)
    x = x + _A_ref(_layernorm(x, axis=-1), A_k_cache, A_v_cache, A_wq, A_wo)
    x = x + _B_ref(_layernorm(x, axis=-1), B_k_cache, B_v_cache, B_wq, B_wo)
    return x
```

```asm
; @launch grid=(256,1,1) block=(256,1,1) lds=163840
.amdgcn_target "amdgcn-amd-amdhsa--gfx950"
.text
.globl interleave_layers__sliding_block_cached__sliding_block_cached__decode_kernel
.p2align 8
.type interleave_layers__sliding_block_cached__sliding_block_cached__decode_kernel,@function
interleave_layers__sliding_block_cached__sliding_block_cached__decode_kernel:
    s_cmp_ge_u32 s2, 256
    s_cbranch_scc1 L_end
    s_load_dwordx4 s[16:19], s[0:1], 8
    s_load_dwordx4 s[20:23], s[0:1], 48
    s_load_dwordx4 s[24:27], s[0:1], 24
    s_load_dwordx4 s[28:31], s[0:1], 64
    s_load_dwordx2 s[32:33], s[0:1], 0
    s_load_dwordx2 s[14:15], s[0:1], 80
    s_load_dwordx2 s[10:11], s[0:1], 96
    v_lshrrev_b32 v1, 6, v0
    v_and_b32 v0, 63, v0
    v_readfirstlane_b32 s3, v1
    s_and_b32 s4, s2, 7
    s_lshr_b32 s5, s2, 3
    s_lshr_b32 s6, s5, 3
    s_bfe_u32 s7, s5, 0x10002
    s_and_b32 s8, s5, 3
    s_and_b32 s9, s5, 3
    s_bfe_u32 s45, s5, 0x20001
    s_mov_b32 s34, 0x3e0293ee
    s_mov_b32 s35, 0xffffff00
    s_mov_b32 s36, 0xffff0000
    s_mov_b32 s37, 0x07060302
    s_mov_b32 s13, 0
    s_lshl_b32 s40, s8, 1
    s_lshr_b32 s41, s5, 2
    s_add_u32 s40, s40, s41
    s_add_u32 s39, s40, s3
    s_and_b32 s40, s40, 7
    s_and_b32 s39, s39, 7
    s_mov_b32 s46, 0xffff
    s_mov_b32 s47, 0
    s_mov_b32 s56, 0xaaaaaaaa
    s_mov_b32 s57, 0xaaaaaaaa
    v_and_b32 v9, 15, v0
    v_lshrrev_b32 v10, 4, v0
    v_lshlrev_b32 v6, 8, v9
    v_lshl_add_u32 v6, v10, 4, v6
    v_lshlrev_b32 v11, 1, v10
    v_xor_b32 v11, v11, v9
    v_lshlrev_b32 v11, 4, v11
    v_lshl_add_u32 v7, v10, 8, v11
    v_xor_b32 v8, 128, v7
    v_lshrrev_b32 v11, 2, v9
    v_and_b32 v12, 1, v10
    v_lshrrev_b32 v13, 1, v10
    v_xor_b32 v14, v12, v13
    v_lshl_add_u32 v14, v14, 2, v11
    v_lshl_add_u32 v11, v13, 2, v11
    v_lshl_add_u32 v11, v12, 5, v11
    v_lshlrev_b32 v12, 5, v14
    v_lshl_add_u32 v12, v11, 8, v12
    v_and_b32 v13, 3, v9
    v_lshl_add_u32 v12, v13, 3, v12
    s_lshl_b32 s41, s3, 15
    v_add_u32 v2, s41, v12
    v_lshlrev_b32 v12, 4, v10
    v_add_u32 v5, 153600, v12
    v_mul_u32_u24 v4, 320, v13
    v_add_u32 v4, v4, v12
    v_add_u32 v4, 150528, v4
    s_lshl_b32 s41, s7, 5
    s_lshl_b32 s42, s4, 2
    s_add_u32 s41, s41, s42
    s_add_u32 s41, s41, s6
    s_lshl_b32 s41, s41, 13
    s_lshl_b32 s42, s8, 9
    s_add_u32 s41, s41, s42
    s_add_u32 s41, s41, 6144
    s_lshl_b32 s51, s41, 8
    s_lshl_b32 s42, s3, 7
    s_add_u32 s41, s41, s42
    s_lshl_b32 s41, s41, 8
    s_mov_b32 s42, s41
    s_lshl_b32 s43, s45, 20
    s_lshl_b32 s44, s3, 18
    s_add_u32 s43, s43, s44
    s_lshl_b32 s44, s4, 10
    s_add_u32 s43, s43, s44
    s_lshl_b32 s44, s6, 8
    s_add_u32 s43, s43, s44
    s_and_b32 s44, s5, 1
    s_lshl_b32 s44, s44, 7
    s_add_u32 s43, s43, s44
    s_waitcnt lgkmcnt(0)
    s_load_dword s12, s[10:11], 0
    s_add_u32 s52, s22, s51
    s_addc_u32 s53, s23, 0
    s_add_u32 s16, s16, s42
    s_addc_u32 s17, s17, 0
    s_add_u32 s20, s20, s42
    s_addc_u32 s21, s21, 0
    s_add_u32 s18, s18, s41
    s_addc_u32 s19, s19, 0
    s_add_u32 s22, s22, s41
    s_addc_u32 s23, s23, 0
    s_add_u32 s24, s24, s43
    s_addc_u32 s25, s25, 0
    s_add_u32 s28, s28, s43
    s_addc_u32 s29, s29, 0
    s_lshl_b32 s43, s4, 19
    s_lshl_b32 s44, s9, 17
    s_add_u32 s43, s43, s44
    s_lshl_b32 s44, s3, 15
    s_add_u32 s43, s43, s44
    s_lshr_b32 s44, s5, 2
    s_lshl_b32 s44, s44, 7
    s_add_u32 s43, s43, s44
    s_add_u32 s26, s26, s43
    s_addc_u32 s27, s27, 0
    s_add_u32 s30, s30, s43
    s_addc_u32 s31, s31, 0
    s_getpc_b64 s[48:49]
L_pc:
    s_lshl_b32 s41, s5, 2
    s_add_u32 s41, s41, s3
    s_cmp_ge_u32 s41, (L_end-L_pc+4095)/4096
    s_cbranch_scc1 Lpf_1
    s_lshl_b32 s41, s41, 12
    v_lshlrev_b32 v75, 6, v0
    v_add_u32 v75, s41, v75
    v_min_u32 v75, L_end-L_pc-4, v75
    global_load_dword v75, v75, s[48:49]
Lpf_1:
    v_lshrrev_b32 v9, 3, v0
    v_mul_u32_u24 v9, 8192, v9
    v_and_b32 v10, 7, v0
    v_lshl_add_u32 v9, v10, 4, v9
    s_lshl_b32 s41, s3, 12
    s_add_u32 s41, s41, 131072
    s_mov_b32 m0, s41
    s_nop 0
    global_load_lds_dwordx4 v9, s[24:25] nt
    s_add_u32 s24, s24, 65536
    s_addc_u32 s25, s25, 0
    s_add_u32 s41, s41, 1024
    s_mov_b32 m0, s41
    s_nop 0
    global_load_lds_dwordx4 v9, s[24:25] nt
    s_add_u32 s24, s24, 65536
    s_addc_u32 s25, s25, 0
    s_add_u32 s41, s41, 1024
    s_mov_b32 m0, s41
    s_nop 0
    global_load_lds_dwordx4 v9, s[24:25] nt
    s_add_u32 s24, s24, 65536
    s_addc_u32 s25, s25, 0
    s_add_u32 s41, s41, 1024
    s_mov_b32 m0, s41
    s_nop 0
    global_load_lds_dwordx4 v9, s[24:25] nt
    v_bfe_u32 v9, v0, 4, 1
    v_lshlrev_b32 v9, 10, v9
    v_and_b32 v10, 15, v0
    v_lshl_add_u32 v9, v10, 4, v9
    s_lshl_b32 s41, s45, 8
    v_add_u32 v9, s41, v9
    global_load_dwordx4 v[32:35], v9, s[32:33]
    s_lshl_b32 s41, s7, 10
    v_lshlrev_b32 v9, 4, v0
    v_add_u32 v9, s41, v9
    global_load_dwordx4 v[36:39], v9, s[32:33]
    v_and_b32 v9, 7, v0
    v_lshrrev_b32 v10, 4, v0
    v_lshl_add_u32 v9, v9, 2, v10
    v_lshrrev_b32 v10, 4, v9
    v_and_b32 v9, 15, v9
    v_lshlrev_b32 v10, 9, v10
    v_add_u32 v9, v9, v10
    s_lshl_b32 s41, s5, 4
    v_add_u32 v9, s41, v9
    v_lshlrev_b32 v9, 1, v9
    global_load_ushort v3, v9, s[32:33]
    s_add_u32 s42, s39, 0
    s_and_b32 s42, s42, 7
    s_lshl_b32 s42, s42, 12
    s_add_u32 s54, s16, s42
    s_addc_u32 s55, s17, 0
    global_load_dwordx4 a[0:3], v6, s[54:55] offset:0 nt
    global_load_dwordx4 a[4:7], v6, s[54:55] offset:64 nt
    global_load_dwordx4 a[8:11], v6, s[54:55] offset:128 nt
    global_load_dwordx4 a[12:15], v6, s[54:55] offset:192 nt
    s_add_u32 s42, s39, 1
    s_and_b32 s42, s42, 7
    s_lshl_b32 s42, s42, 12
    s_add_u32 s54, s16, s42
    s_addc_u32 s55, s17, 0
    global_load_dwordx4 a[16:19], v6, s[54:55] offset:0 nt
    global_load_dwordx4 a[20:23], v6, s[54:55] offset:64 nt
    global_load_dwordx4 a[24:27], v6, s[54:55] offset:128 nt
    global_load_dwordx4 a[28:31], v6, s[54:55] offset:192 nt
    s_add_u32 s42, s39, 2
    s_and_b32 s42, s42, 7
    s_lshl_b32 s42, s42, 12
    s_add_u32 s54, s16, s42
    s_addc_u32 s55, s17, 0
    global_load_dwordx4 a[32:35], v6, s[54:55] offset:0 nt
    global_load_dwordx4 a[36:39], v6, s[54:55] offset:64 nt
    global_load_dwordx4 a[40:43], v6, s[54:55] offset:128 nt
    global_load_dwordx4 a[44:47], v6, s[54:55] offset:192 nt
    s_add_u32 s42, s39, 3
    s_and_b32 s42, s42, 7
    s_lshl_b32 s42, s42, 12
    s_add_u32 s54, s16, s42
    s_addc_u32 s55, s17, 0
    global_load_dwordx4 a[48:51], v6, s[54:55] offset:0 nt
    global_load_dwordx4 a[52:55], v6, s[54:55] offset:64 nt
    global_load_dwordx4 a[56:59], v6, s[54:55] offset:128 nt
    global_load_dwordx4 a[60:63], v6, s[54:55] offset:192 nt
    s_waitcnt lgkmcnt(0)
    s_add_u32 s12, s12, 1
    v_mov_b32 v1, s12
    s_and_b32 s50, s12, 0xff
    s_cmp_lg_u32 s3, 0
    s_cbranch_scc1 Lw1_2
    s_getreg_b32 s41, hwreg(HW_REG_XCC_ID)
    s_and_b32 s41, s41, 15
    v_mov_b32 v40, s12
    v_mov_b32 v41, s41
    v_mov_b32 v42, s12
    v_mov_b32 v43, s12
    s_lshl_b32 s41, s4, 9
    s_lshl_b32 s42, s5, 4
    s_add_u32 s41, s41, s42
    s_add_u32 s41, s41, 4096
    v_mov_b32 v9, s41
    s_mov_b64 exec, 1
    global_store_dwordx4 v9, v[40:43], s[10:11] sc1
    s_mov_b64 exec, -1
Lw1_2:
    v_and_b32 v9, 15, v0
    v_lshlrev_b32 v9, 4, v9
    v_bfe_u32 v10, v0, 4, 1
    v_mul_u32_u24 v10, 320, v10
    v_add_u32 v9, v9, v10
    v_add_u32 v9, 152064, v9
    v_mov_b32 v44, 0x3f803f80
    v_mov_b32 v45, 0x3f803f80
    v_mov_b32 v46, 0x3f803f80
    v_mov_b32 v47, 0x3f803f80
    v_lshrrev_b32 v12, 4, v0
    v_lshlrev_b32 v12, 3, v12
    v_bfe_u32 v15, v0, 2, 2
    v_add_u32 v12, v12, v15
    v_lshlrev_b32 v12, 7, v12
    v_and_b32 v15, 3, v0
    v_lshl_add_u32 v12, v15, 3, v12
    s_lshl_b32 s41, s3, 5
    s_add_u32 s41, s41, 131072
    v_add_u32 v12, s41, v12
    s_lshl_b32 s41, s4, 14
    s_lshl_b32 s44, s6, 12
    s_add_u32 s41, s41, s44
    s_add_u32 s41, s41, 1048576
    s_lshl_b32 s42, s45, 10
    s_add_u32 s41, s41, s42
    s_and_b32 s42, s5, 1
    s_lshl_b32 s42, s42, 2
    s_add_u32 s42, s42, s3
    s_lshl_b32 s43, s42, 7
    s_add_u32 s41, s41, s43
    v_and_b32 v14, 31, v0
    v_lshlrev_b32 v14, 2, v14
    v_add_u32 v14, s41, v14
    s_lshl_b32 s41, s4, 13
    s_lshl_b32 s44, s6, 11
    s_add_u32 s41, s41, s44
    s_add_u32 s41, s41, 327680
    s_lshl_b32 s43, s45, 9
    s_add_u32 s41, s41, s43
    s_lshl_b32 s42, s42, 6
    s_add_u32 s41, s41, s42
    v_and_b32 v13, 15, v0
    v_lshlrev_b32 v13, 2, v13
    v_add_u32 v13, s41, v13
    s_waitcnt vmcnt(16)
    v_lshlrev_b32 v3, 16, v3
    s_cmp_lg_u32 s3, 0
    s_cbranch_scc1 Lw1_4
    ds_write_b128 v9, v[44:47] offset:640
    ds_write_b128 v9, v[32:35]
Lw1_4:
    s_waitcnt lgkmcnt(0)
    s_barrier
    ds_read_b64_tr_b16 v[80:81], v12 offset:0
    ds_read_b64_tr_b16 v[82:83], v12 offset:512
    ds_read_b64_tr_b16 v[84:85], v12 offset:4096
    ds_read_b64_tr_b16 v[86:87], v12 offset:4608
    ds_read_b64_tr_b16 v[88:89], v12 offset:8192
    ds_read_b64_tr_b16 v[90:91], v12 offset:8704
    ds_read_b64_tr_b16 v[92:93], v12 offset:12288
    ds_read_b64_tr_b16 v[94:95], v12 offset:12800
    ds_read_b128 v[16:19], v4 offset:1536
    ds_read_b128 v[20:23], v4 offset:1600
    ds_read_b128 v[24:27], v4 offset:1664
    ds_read_b128 v[28:31], v4 offset:1728
    s_waitcnt lgkmcnt(3)
    v_mfma_f32_16x16x32_bf16 v[56:59], v[16:19], v[80:83], 0
    s_waitcnt lgkmcnt(2)
    v_mfma_f32_16x16x32_bf16 v[56:59], v[20:23], v[84:87], v[56:59]
    s_waitcnt lgkmcnt(1)
    v_mfma_f32_16x16x32_bf16 v[56:59], v[24:27], v[88:91], v[56:59]
    s_waitcnt lgkmcnt(0)
    v_mfma_f32_16x16x32_bf16 v[56:59], v[28:31], v[92:95], v[56:59]
    s_nop 7
    v_cndmask_b32 v32, v57, v56, s[46:47]
    v_bfi_b32 v32, s35, v32, v1
    v_bfi_b32 v58, s35, v58, v1
    s_mov_b32 exec_lo, 0xffffffff
    s_mov_b32 exec_hi, 0
    global_store_dword v14, v32, s[10:11] sc1
    s_mov_b32 exec_lo, 0xffff
    s_mov_b32 exec_hi, 0
    global_store_dword v13, v58, s[10:11] sc1
    s_mov_b64 exec, -1
    v_lshlrev_b32 v40, 16, v36
    v_and_b32 v41, 0xffff0000, v36
    v_lshlrev_b32 v42, 16, v37
    v_and_b32 v43, 0xffff0000, v37
    v_lshlrev_b32 v44, 16, v38
    v_and_b32 v45, 0xffff0000, v38
    v_lshlrev_b32 v46, 16, v39
    v_and_b32 v47, 0xffff0000, v39
    v_add_f32 v48, v40, v41
    v_mul_f32 v49, v40, v40
    v_fmac_f32 v49, v41, v41
    v_add_f32 v48, v48, v42
    v_fmac_f32 v49, v42, v42
    v_add_f32 v48, v48, v43
    v_fmac_f32 v49, v43, v43
    v_add_f32 v48, v48, v44
    v_fmac_f32 v49, v44, v44
    v_add_f32 v48, v48, v45
    v_fmac_f32 v49, v45, v45
    v_add_f32 v48, v48, v46
    v_fmac_f32 v49, v46, v46
    v_add_f32 v48, v48, v47
    v_fmac_f32 v49, v47, v47
    s_nop 0
    v_add_f32_dpp v48, v48, v48 row_ror:8 row_mask:0xf bank_mask:0xf
    v_add_f32_dpp v49, v49, v49 row_ror:8 row_mask:0xf bank_mask:0xf
    s_nop 0
    v_add_f32_dpp v48, v48, v48 row_ror:4 row_mask:0xf bank_mask:0xf
    v_add_f32_dpp v49, v49, v49 row_ror:4 row_mask:0xf bank_mask:0xf
    s_nop 0
    v_add_f32_dpp v48, v48, v48 row_ror:2 row_mask:0xf bank_mask:0xf
    v_add_f32_dpp v49, v49, v49 row_ror:2 row_mask:0xf bank_mask:0xf
    s_nop 0
    v_add_f32_dpp v48, v48, v48 row_ror:1 row_mask:0xf bank_mask:0xf
    v_add_f32_dpp v49, v49, v49 row_ror:1 row_mask:0xf bank_mask:0xf
    v_mov_b32 v50, v48
    v_mov_b32 v51, v49
    s_nop 0
    v_permlane16_swap_b32 v48, v50
    v_permlane16_swap_b32 v49, v51
    v_add_f32 v48, v48, v50
    v_add_f32 v49, v49, v51
    v_mov_b32 v50, v48
    v_mov_b32 v51, v49
    s_nop 0
    v_permlane32_swap_b32 v48, v50
    v_permlane32_swap_b32 v49, v51
    v_add_f32 v48, v48, v50
    v_add_f32 v49, v49, v51
    v_mul_f32 v76, 0x3b000000, v48
    v_mul_f32 v49, 0x3b000000, v49
    v_fma_f32 v49, -v76, v76, v49
    v_max_f32 v49, 0, v49
    v_add_f32 v49, 0x3727c5ac, v49
    v_rsq_f32 v77, v49
    s_add_u32 s42, s39, 4
    s_and_b32 s42, s42, 7
    s_lshl_b32 s42, s42, 12
    s_add_u32 s54, s16, s42
    s_addc_u32 s55, s17, 0
    s_waitcnt vmcnt(15)
    global_load_dwordx4 a[64:67], v6, s[54:55] offset:0 nt
    s_waitcnt vmcnt(15)
    global_load_dwordx4 a[68:71], v6, s[54:55] offset:64 nt
    s_waitcnt vmcnt(15)
    global_load_dwordx4 a[72:75], v6, s[54:55] offset:128 nt
    s_waitcnt vmcnt(15)
    global_load_dwordx4 a[76:79], v6, s[54:55] offset:192 nt
    s_add_u32 s42, s39, 5
    s_and_b32 s42, s42, 7
    s_lshl_b32 s42, s42, 12
    s_add_u32 s54, s16, s42
    s_addc_u32 s55, s17, 0
    s_waitcnt vmcnt(15)
    global_load_dwordx4 a[80:83], v6, s[54:55] offset:0 nt
    s_waitcnt vmcnt(15)
    global_load_dwordx4 a[84:87], v6, s[54:55] offset:64 nt
    s_waitcnt vmcnt(15)
    global_load_dwordx4 a[88:91], v6, s[54:55] offset:128 nt
    s_waitcnt vmcnt(15)
    global_load_dwordx4 a[92:95], v6, s[54:55] offset:192 nt
    s_add_u32 s42, s39, 6
    s_and_b32 s42, s42, 7
    s_lshl_b32 s42, s42, 12
    s_add_u32 s54, s16, s42
    s_addc_u32 s55, s17, 0
    s_waitcnt vmcnt(15)
    global_load_dwordx4 a[96:99], v6, s[54:55] offset:0 nt
    s_waitcnt vmcnt(15)
    global_load_dwordx4 a[100:103], v6, s[54:55] offset:64 nt
    s_waitcnt vmcnt(15)
    global_load_dwordx4 a[104:107], v6, s[54:55] offset:128 nt
    s_waitcnt vmcnt(15)
    global_load_dwordx4 a[108:111], v6, s[54:55] offset:192 nt
    s_add_u32 s42, s39, 7
    s_and_b32 s42, s42, 7
    s_lshl_b32 s42, s42, 12
    s_add_u32 s54, s16, s42
    s_addc_u32 s55, s17, 0
    s_waitcnt vmcnt(15)
    global_load_dwordx4 a[112:115], v6, s[54:55] offset:0 nt
    s_waitcnt vmcnt(15)
    global_load_dwordx4 a[116:119], v6, s[54:55] offset:64 nt
    s_waitcnt vmcnt(15)
    global_load_dwordx4 a[120:123], v6, s[54:55] offset:128 nt
    s_waitcnt vmcnt(15)
    global_load_dwordx4 a[124:127], v6, s[54:55] offset:192 nt
    s_add_u32 s42, s39, 0
    s_and_b32 s42, s42, 7
    s_lshl_b32 s42, s42, 12
    s_add_u32 s54, s18, s42
    s_addc_u32 s55, s19, 0
    s_lshl_b32 s41, s3, 15
    s_add_u32 s41, s41, 0
    s_mov_b32 m0, s41
    s_waitcnt vmcnt(15)
    global_load_lds_dwordx4 v7, s[54:55] offset:0 nt
    s_waitcnt vmcnt(15)
    global_load_lds_dwordx4 v8, s[54:55] offset:1024 nt
    s_waitcnt vmcnt(15)
    global_load_lds_dwordx4 v7, s[54:55] offset:2048 nt
    s_waitcnt vmcnt(15)
    global_load_lds_dwordx4 v8, s[54:55] offset:3072 nt
    s_add_u32 s42, s39, 1
    s_and_b32 s42, s42, 7
    s_lshl_b32 s42, s42, 12
    s_add_u32 s54, s18, s42
    s_addc_u32 s55, s19, 0
    s_lshl_b32 s41, s3, 15
    s_add_u32 s41, s41, 4096
    s_mov_b32 m0, s41
    s_waitcnt vmcnt(15)
    global_load_lds_dwordx4 v7, s[54:55] offset:0 nt
    s_waitcnt vmcnt(15)
    global_load_lds_dwordx4 v8, s[54:55] offset:1024 nt
    s_waitcnt vmcnt(15)
    global_load_lds_dwordx4 v7, s[54:55] offset:2048 nt
    s_waitcnt vmcnt(15)
    global_load_lds_dwordx4 v8, s[54:55] offset:3072 nt
    v_and_b32 v14, 31, v0
    v_lshlrev_b32 v14, 4, v14
    s_lshl_b32 s41, s4, 9
    s_add_u32 s41, s41, 4096
    v_add_u32 v14, s41, v14
    global_load_dwordx4 v[72:75], v14, s[10:11] sc1
    s_lshl_b32 s41, s4, 14
    s_lshl_b32 s44, s6, 12
    s_add_u32 s41, s41, s44
    s_add_u32 s41, s41, 1048576
    s_lshl_b32 s42, s7, 6
    s_add_u32 s41, s41, s42
    v_lshrrev_b32 v9, 3, v0
    v_lshlrev_b32 v9, 7, v9
    v_and_b32 v11, 7, v0
    v_lshl_add_u32 v9, v11, 3, v9
    v_add_u32 v9, s41, v9
    s_lshl_b32 s41, s4, 13
    s_lshl_b32 s44, s6, 11
    s_add_u32 s41, s41, s44
    s_add_u32 s41, s41, 327680
    v_lshlrev_b32 v10, 3, v0
    v_add_u32 v10, s41, v10
    v_lshlrev_b32 v11, 2, v0
    v_add_u32 v11, 153600, v11
    s_cmp_lg_u32 s3, 0
    s_cbranch_scc1 Lw1_6
    global_load_dwordx2 v[32:33], v9, s[10:11] offset:0 sc1
    global_load_dwordx2 v[34:35], v9, s[10:11] offset:1024 sc1
    global_load_dwordx2 v[36:37], v9, s[10:11] offset:2048 sc1
    global_load_dwordx2 v[38:39], v9, s[10:11] offset:3072 sc1
    global_load_dwordx2 v[40:41], v10, s[10:11] offset:0 sc1
    global_load_dwordx2 v[42:43], v10, s[10:11] offset:512 sc1
    global_load_dwordx2 v[44:45], v10, s[10:11] offset:1024 sc1
    global_load_dwordx2 v[46:47], v10, s[10:11] offset:1536 sc1
Lw1_6:
    s_add_u32 s42, s39, 2
    s_and_b32 s42, s42, 7
    s_lshl_b32 s42, s42, 12
    s_add_u32 s54, s18, s42
    s_addc_u32 s55, s19, 0
    s_lshl_b32 s41, s3, 15
    s_add_u32 s41, s41, 8192
    s_mov_b32 m0, s41
    s_nop 0
    global_load_lds_dwordx4 v8, s[54:55] offset:0 nt
    global_load_lds_dwordx4 v7, s[54:55] offset:1024 nt
    global_load_lds_dwordx4 v8, s[54:55] offset:2048 nt
    global_load_lds_dwordx4 v7, s[54:55] offset:3072 nt
    s_add_u32 s42, s39, 3
    s_and_b32 s42, s42, 7
    s_lshl_b32 s42, s42, 12
    s_add_u32 s54, s18, s42
    s_addc_u32 s55, s19, 0
    s_lshl_b32 s41, s3, 15
    s_add_u32 s41, s41, 12288
    s_mov_b32 m0, s41
    s_nop 0
    global_load_lds_dwordx4 v8, s[54:55] offset:0 nt
    global_load_lds_dwordx4 v7, s[54:55] offset:1024 nt
    global_load_lds_dwordx4 v8, s[54:55] offset:2048 nt
    global_load_lds_dwordx4 v7, s[54:55] offset:3072 nt
    s_add_u32 s42, s39, 4
    s_and_b32 s42, s42, 7
    s_lshl_b32 s42, s42, 12
    s_add_u32 s54, s18, s42
    s_addc_u32 s55, s19, 0
    s_lshl_b32 s41, s3, 15
    s_add_u32 s41, s41, 16384
    s_mov_b32 m0, s41
    s_nop 0
    global_load_lds_dwordx4 v7, s[54:55] offset:0 nt
    global_load_lds_dwordx4 v8, s[54:55] offset:1024 nt
    global_load_lds_dwordx4 v7, s[54:55] offset:2048 nt
    global_load_lds_dwordx4 v8, s[54:55] offset:3072 nt
    s_waitcnt vmcnt(11)
    v_xor_b32 v15, v72, v1
    v_bitop3_b32 v15, v74, v15, v1 bitop3:0xDE
    v_bitop3_b32 v15, v75, v15, v1 bitop3:0xDE
    v_cmp_eq_u32 vcc, 0, v15
    s_nop 0
    s_cmp_eq_u64 vcc, exec
    s_cbranch_scc1 Lok_8
    s_mov_b32 s38, 0
Lpoll_9:
    global_load_dwordx4 v[72:75], v14, s[10:11] sc1
    s_waitcnt vmcnt(0)
    v_xor_b32 v15, v72, v1
    v_bitop3_b32 v15, v74, v15, v1 bitop3:0xDE
    v_bitop3_b32 v15, v75, v15, v1 bitop3:0xDE
    v_cmp_eq_u32 vcc, 0, v15
    s_nop 0
    s_cmp_eq_u64 vcc, exec
    s_cbranch_scc1 Lpdone_10
Lpretry_11:
    s_add_u32 s38, s38, 1
    s_cmp_lt_u32 s38, 65536
    s_cbranch_scc1 Lpoll_9
Lpdone_10:
Lok_8:
    s_getreg_b32 s41, hwreg(HW_REG_XCC_ID)
    s_and_b32 s41, s41, 15
    v_cmp_eq_u32 vcc, s41, v73
    s_nop 0
    s_cmp_eq_u64 vcc, exec
    s_cselect_b32 s13, 1, 0
    s_cmp_lg_u32 s3, 0
    s_cbranch_scc1 Lw1_12
    v_xor_b32 v32, s50, v32
    v_xor_b32 v33, s50, v33
    v_xor_b32 v34, s50, v34
    v_xor_b32 v35, s50, v35
    v_xor_b32 v36, s50, v36
    v_xor_b32 v37, s50, v37
    v_xor_b32 v38, s50, v38
    v_xor_b32 v39, s50, v39
    v_xor_b32 v40, s50, v40
    v_xor_b32 v41, s50, v41
    v_xor_b32 v42, s50, v42
    v_xor_b32 v43, s50, v43
    v_xor_b32 v44, s50, v44
    v_xor_b32 v45, s50, v45
    v_xor_b32 v46, s50, v46
    v_xor_b32 v47, s50, v47
    v_or3_b32 v15, v32, v33, v34
    v_or3_b32 v15, v15, v35, v36
    v_or3_b32 v15, v15, v37, v38
    v_or3_b32 v15, v15, v39, v40
    v_or3_b32 v15, v15, v41, v42
    v_or3_b32 v15, v15, v43, v44
    v_or3_b32 v15, v15, v45, v46
    v_or_b32 v15, v15, v47
    v_and_b32 v15, 0xff, v15
    v_cmp_eq_u32 vcc, 0, v15
    s_nop 0
    s_cmp_eq_u64 vcc, exec
    s_cbranch_scc1 Lok_14
    s_mov_b32 s38, 0
Lpoll_15:
    global_load_dwordx2 v[32:33], v9, s[10:11] offset:0 sc1
    global_load_dwordx2 v[34:35], v9, s[10:11] offset:1024 sc1
    global_load_dwordx2 v[36:37], v9, s[10:11] offset:2048 sc1
    global_load_dwordx2 v[38:39], v9, s[10:11] offset:3072 sc1
    global_load_dwordx2 v[40:41], v10, s[10:11] offset:0 sc1
    global_load_dwordx2 v[42:43], v10, s[10:11] offset:512 sc1
    global_load_dwordx2 v[44:45], v10, s[10:11] offset:1024 sc1
    global_load_dwordx2 v[46:47], v10, s[10:11] offset:1536 sc1
    s_waitcnt vmcnt(0)
    v_xor_b32 v32, s50, v32
    v_xor_b32 v33, s50, v33
    v_xor_b32 v34, s50, v34
    v_xor_b32 v35, s50, v35
    v_xor_b32 v36, s50, v36
    v_xor_b32 v37, s50, v37
    v_xor_b32 v38, s50, v38
    v_xor_b32 v39, s50, v39
    v_xor_b32 v40, s50, v40
    v_xor_b32 v41, s50, v41
    v_xor_b32 v42, s50, v42
    v_xor_b32 v43, s50, v43
    v_xor_b32 v44, s50, v44
    v_xor_b32 v45, s50, v45
    v_xor_b32 v46, s50, v46
    v_xor_b32 v47, s50, v47
    v_or3_b32 v15, v32, v33, v34
    v_or3_b32 v15, v15, v35, v36
    v_or3_b32 v15, v15, v37, v38
    v_or3_b32 v15, v15, v39, v40
    v_or3_b32 v15, v15, v41, v42
    v_or3_b32 v15, v15, v43, v44
    v_or3_b32 v15, v15, v45, v46
    v_or_b32 v15, v15, v47
    v_and_b32 v15, 0xff, v15
    v_cmp_eq_u32 vcc, 0, v15
    s_nop 0
    s_cmp_eq_u64 vcc, exec
    s_cbranch_scc1 Lpdone_16
Lpretry_17:
    s_add_u32 s38, s38, 1
    s_cmp_lt_u32 s38, 65536
    s_cbranch_scc1 Lpoll_15
Lpdone_16:
Lok_14:
    v_add_f32 v32, v32, v34
    v_add_f32 v36, v36, v38
    v_add_f32 v33, v33, v35
    v_add_f32 v37, v37, v39
    v_add_f32 v32, v32, v36
    v_add_f32 v33, v33, v37
    v_add_f32 v40, v40, v42
    v_add_f32 v44, v44, v46
    v_add_f32 v41, v41, v43
    v_add_f32 v45, v45, v47
    v_add_f32 v40, v40, v44
    v_add_f32 v41, v41, v45
    v_lshlrev_b32 v10, 3, v0
    v_add_u32 v10, 153856, v10
    ds_write_b64 v10, v[40:41]
    v_fma_f32 v32, -v76, v40, v32
    v_fma_f32 v33, -v76, v41, v33
    v_mul_f32 v32, v77, v32
    v_mul_f32 v33, v77, v33
    v_cvt_pk_bf16_f32 v32, v32, v33
    ds_write_b32 v11, v32
Lw1_12:
    s_waitcnt lgkmcnt(0)
    s_barrier
    ds_read_b128 v[16:19], v5 offset:0
    ds_read_b128 v[20:23], v5 offset:64
    ds_read_b128 v[24:27], v5 offset:128
    ds_read_b128 v[28:31], v5 offset:192
    s_waitcnt lgkmcnt(0)
    s_cmp_lg_u32 s3, 0
    s_cbranch_scc1 Lw1_18
    s_mov_b32 m0, 155648
    v_lshlrev_b32 v9, 7, v0
    s_lshl_b32 s41, s4, 15
    s_lshl_b32 s42, s5, 10
    s_add_u32 s41, s41, s42
    s_add_u32 s41, s41, 2097152
    v_add_u32 v9, s41, v9
    s_lshl_b32 s41, s4, 14
    s_lshl_b32 s44, s6, 12
    s_add_u32 s41, s41, s44
    s_add_u32 s41, s41, 1179648
    s_lshl_b32 s42, s45, 10
    s_add_u32 s41, s41, s42
    s_and_b32 s42, s5, 1
    s_lshl_b32 s42, s42, 9
    s_add_u32 s41, s41, s42
    v_and_b32 v10, 3, v0
    v_lshlrev_b32 v10, 7, v10
    v_add_u32 v10, s41, v10
    v_cmp_gt_u32 vcc, 8, v0
    s_nop 1
    v_cndmask_b32 v9, v10, v9, vcc
    s_lshl_b32 s41, s4, 13
    s_lshl_b32 s44, s6, 11
    s_add_u32 s41, s41, s44
    s_add_u32 s41, s41, 393216
    s_lshl_b32 s42, s45, 9
    s_add_u32 s41, s41, s42
    s_and_b32 s42, s5, 1
    s_lshl_b32 s42, s42, 8
    s_add_u32 s41, s41, s42
    v_and_b32 v10, 1, v0
    v_lshlrev_b32 v10, 7, v10
    v_add_u32 v10, s41, v10
    v_cmp_gt_u32 vcc, 12, v0
    s_nop 1
    v_cndmask_b32 v9, v10, v9, vcc
    s_lshl_b32 s41, s4, 12
    s_lshl_b32 s42, s5, 7
    s_add_u32 s41, s41, s42
    s_add_u32 s41, s41, 98304
    v_mov_b32 v10, s41
    v_cmp_gt_u32 vcc, 14, v0
    s_nop 1
    v_cndmask_b32 v9, v10, v9, vcc
    s_lshl_b32 s41, s4, 9
    s_lshl_b32 s42, s5, 4
    s_add_u32 s41, s41, s42
    s_add_u32 s41, s41, 266240
    v_mov_b32 v10, s41
    v_cmp_gt_u32 vcc, 15, v0
    s_nop 1
    v_cndmask_b32 v9, v10, v9, vcc
    s_mov_b32 exec_lo, 0xff1f
    s_mov_b32 exec_hi, 0
    global_load_lds_dword v9, s[10:11] sc1
    s_mov_b64 exec, -1
Lw1_18:
    v_not_b32 v15, v1
    s_lshr_b32 s41, s5, 2
    s_lshl_b32 s41, s41, 2
    s_add_u32 s41, s41, s3
    s_lshl_b32 s41, s41, 12
    s_lshl_b32 s42, s4, 2
    s_add_u32 s42, s42, s9
    s_lshl_b32 s42, s42, 7
    s_add_u32 s41, s41, s42
    s_add_u32 s41, s41, 524288
    v_and_b32 v14, 31, v0
    v_lshlrev_b32 v14, 2, v14
    v_add_u32 v14, s41, v14
    s_mov_b32 exec_lo, 0xffffffff
    s_mov_b32 exec_hi, 0
    global_store_dword v14, v15, s[10:11] sc1
    s_mov_b64 exec, -1
    s_add_u32 s42, s39, 5
    s_and_b32 s42, s42, 7
    s_lshl_b32 s42, s42, 12
    s_add_u32 s54, s18, s42
    s_addc_u32 s55, s19, 0
    s_lshl_b32 s41, s3, 15
    s_add_u32 s41, s41, 20480
    s_mov_b32 m0, s41
    s_nop 0
    global_load_lds_dwordx4 v7, s[54:55] offset:0 nt
    global_load_lds_dwordx4 v8, s[54:55] offset:1024 nt
    global_load_lds_dwordx4 v7, s[54:55] offset:2048 nt
    global_load_lds_dwordx4 v8, s[54:55] offset:3072 nt
    s_add_u32 s42, s39, 6
    s_and_b32 s42, s42, 7
    s_lshl_b32 s42, s42, 12
    s_add_u32 s54, s18, s42
    s_addc_u32 s55, s19, 0
    s_lshl_b32 s41, s3, 15
    s_add_u32 s41, s41, 24576
    s_mov_b32 m0, s41
    s_nop 0
    global_load_lds_dwordx4 v8, s[54:55] offset:0 nt
    s_waitcnt vmcnt(15)
    global_load_lds_dwordx4 v7, s[54:55] offset:1024 nt
    s_waitcnt vmcnt(15)
    global_load_lds_dwordx4 v8, s[54:55] offset:2048 nt
    s_waitcnt vmcnt(15)
    global_load_lds_dwordx4 v7, s[54:55] offset:3072 nt
    s_add_u32 s42, s39, 7
    s_and_b32 s42, s42, 7
    s_lshl_b32 s42, s42, 12
    s_add_u32 s54, s18, s42
    s_addc_u32 s55, s19, 0
    s_lshl_b32 s41, s3, 15
    s_add_u32 s41, s41, 28672
    s_mov_b32 m0, s41
    s_waitcnt vmcnt(15)
    global_load_lds_dwordx4 v8, s[54:55] offset:0 nt
    s_waitcnt vmcnt(15)
    global_load_lds_dwordx4 v7, s[54:55] offset:1024 nt
    s_waitcnt vmcnt(15)
    global_load_lds_dwordx4 v8, s[54:55] offset:2048 nt
    s_waitcnt vmcnt(15)
    global_load_lds_dwordx4 v7, s[54:55] offset:3072 nt
    v_lshrrev_b32 v9, 3, v0
    v_mul_u32_u24 v9, 1024, v9
    v_and_b32 v10, 7, v0
    v_lshl_add_u32 v9, v10, 4, v9
    s_lshl_b32 s41, s3, 12
    s_add_u32 s41, s41, 131072
    s_mov_b32 m0, s41
    s_waitcnt vmcnt(15)
    global_load_lds_dwordx4 v9, s[26:27] nt
    s_add_u32 s26, s26, 8192
    s_addc_u32 s27, s27, 0
    s_add_u32 s41, s41, 1024
    s_mov_b32 m0, s41
    s_waitcnt vmcnt(15)
    global_load_lds_dwordx4 v9, s[26:27] nt
    s_add_u32 s26, s26, 8192
    s_addc_u32 s27, s27, 0
    s_add_u32 s41, s41, 1024
    s_mov_b32 m0, s41
    s_waitcnt vmcnt(15)
    global_load_lds_dwordx4 v9, s[26:27] nt
    s_add_u32 s26, s26, 8192
    s_addc_u32 s27, s27, 0
    s_add_u32 s41, s41, 1024
    s_mov_b32 m0, s41
    s_waitcnt vmcnt(15)
    global_load_lds_dwordx4 v9, s[26:27] nt
    v_mfma_f32_16x16x32_bf16 v[32:35], a[0:3], v[16:19], 0
    v_mfma_f32_16x16x32_bf16 v[32:35], a[4:7], v[20:23], v[32:35]
    v_mfma_f32_16x16x32_bf16 v[32:35], a[8:11], v[24:27], v[32:35]
    v_mfma_f32_16x16x32_bf16 v[32:35], a[12:15], v[28:31], v[32:35]
    v_mov_b64 v[64:65], 0
    v_mfma_f32_16x16x32_bf16 v[36:39], a[16:19], v[16:19], 0
    v_mfma_f32_16x16x32_bf16 v[36:39], a[20:23], v[20:23], v[36:39]
    v_mfma_f32_16x16x32_bf16 v[36:39], a[24:27], v[24:27], v[36:39]
    v_mfma_f32_16x16x32_bf16 v[36:39], a[28:31], v[28:31], v[36:39]
    v_mov_b64 v[68:69], 0
    v_mfma_f32_16x16x32_bf16 v[40:43], a[32:35], v[16:19], 0
    v_mfma_f32_16x16x32_bf16 v[40:43], a[36:39], v[20:23], v[40:43]
    v_mfma_f32_16x16x32_bf16 v[40:43], a[40:43], v[24:27], v[40:43]
    v_mfma_f32_16x16x32_bf16 v[40:43], a[44:47], v[28:31], v[40:43]
    v_cndmask_b32 v32, v32, v34, s[56:57]
    v_cndmask_b32 v33, v33, v35, s[56:57]
    v_max_f32 v9, v32, v33
    v_mov_b64 v[72:73], 0
    v_mfma_f32_16x16x32_bf16 v[44:47], a[48:51], v[16:19], 0
    v_mfma_f32_16x16x32_bf16 v[44:47], a[52:55], v[20:23], v[44:47]
    v_mfma_f32_16x16x32_bf16 v[44:47], a[56:59], v[24:27], v[44:47]
    v_mfma_f32_16x16x32_bf16 v[44:47], a[60:63], v[28:31], v[44:47]
    v_cndmask_b32 v34, v36, v38, s[56:57]
    v_cndmask_b32 v35, v37, v39, s[56:57]
    v_max3_f32 v9, v9, v34, v35
    v_mov_b64 v[76:77], 0
    v_mfma_f32_16x16x32_bf16 v[48:51], a[64:67], v[16:19], 0
    v_mfma_f32_16x16x32_bf16 v[48:51], a[68:71], v[20:23], v[48:51]
    v_mfma_f32_16x16x32_bf16 v[48:51], a[72:75], v[24:27], v[48:51]
    v_mfma_f32_16x16x32_bf16 v[48:51], a[76:79], v[28:31], v[48:51]
    v_cndmask_b32 v36, v40, v42, s[56:57]
    v_cndmask_b32 v37, v41, v43, s[56:57]
    v_max3_f32 v9, v9, v36, v37
    v_mfma_f32_16x16x32_bf16 v[52:55], a[80:83], v[16:19], 0
    v_mfma_f32_16x16x32_bf16 v[52:55], a[84:87], v[20:23], v[52:55]
    v_mfma_f32_16x16x32_bf16 v[52:55], a[88:91], v[24:27], v[52:55]
    v_mfma_f32_16x16x32_bf16 v[52:55], a[92:95], v[28:31], v[52:55]
    v_cndmask_b32 v38, v44, v46, s[56:57]
    v_cndmask_b32 v39, v45, v47, s[56:57]
    v_max3_f32 v9, v9, v38, v39
    v_mfma_f32_16x16x32_bf16 v[56:59], a[96:99], v[16:19], 0
    v_mfma_f32_16x16x32_bf16 v[56:59], a[100:103], v[20:23], v[56:59]
    v_mfma_f32_16x16x32_bf16 v[56:59], a[104:107], v[24:27], v[56:59]
    v_mfma_f32_16x16x32_bf16 v[56:59], a[108:111], v[28:31], v[56:59]
    v_cndmask_b32 v40, v48, v50, s[56:57]
    v_cndmask_b32 v41, v49, v51, s[56:57]
    v_max3_f32 v9, v9, v40, v41
    v_mfma_f32_16x16x32_bf16 v[60:63], a[112:115], v[16:19], 0
    v_mfma_f32_16x16x32_bf16 v[60:63], a[116:119], v[20:23], v[60:63]
    v_mfma_f32_16x16x32_bf16 v[60:63], a[120:123], v[24:27], v[60:63]
    v_mfma_f32_16x16x32_bf16 v[60:63], a[124:127], v[28:31], v[60:63]
    v_cndmask_b32 v42, v52, v54, s[56:57]
    v_cndmask_b32 v43, v53, v55, s[56:57]
    v_max3_f32 v9, v9, v42, v43
    v_mov_b32 v14, 0x44444444
    v_mov_b32 v15, 0xeeeeeeee
    v_cndmask_b32 v14, v14, v15, s[56:57]
    v_cndmask_b32 v44, v56, v58, s[56:57]
    v_cndmask_b32 v45, v57, v59, s[56:57]
    v_max3_f32 v9, v9, v44, v45
    v_cndmask_b32 v46, v60, v62, s[56:57]
    v_cndmask_b32 v47, v61, v63, s[56:57]
    v_max3_f32 v9, v9, v46, v47
    s_nop 1
    v_max_f32_dpp v9, v9, v9 quad_perm:[1,0,3,2] row_mask:0xf bank_mask:0xf
    v_mov_b32 v10, v9
    s_nop 1
    v_permlane16_swap_b32 v9, v10
    v_max_f32 v9, v9, v10
    v_mov_b32 v10, v9
    s_nop 1
    v_permlane32_swap_b32 v9, v10
    v_max_f32 v9, v9, v10
    v_mul_f32 v12, s34, v9
    v_mov_b64 v[16:17], 0
    v_mov_b64 v[20:21], 0
    v_mov_b64 v[24:25], 0
    v_mov_b64 v[28:29], 0
    v_fma_f32 v32, v32, s34, -v12
    v_fma_f32 v33, v33, s34, -v12
    v_fma_f32 v34, v34, s34, -v12
    v_fma_f32 v35, v35, s34, -v12
    v_fma_f32 v36, v36, s34, -v12
    v_fma_f32 v37, v37, s34, -v12
    v_fma_f32 v38, v38, s34, -v12
    v_fma_f32 v39, v39, s34, -v12
    v_exp_f32 v32, v32
    v_exp_f32 v33, v33
    v_exp_f32 v34, v34
    v_exp_f32 v35, v35
    v_exp_f32 v36, v36
    v_exp_f32 v37, v37
    v_exp_f32 v38, v38
    v_exp_f32 v39, v39
    v_cvt_pk_bf16_f32 v48, v32, v33
    v_cvt_pk_bf16_f32 v49, v34, v35
    v_cvt_pk_bf16_f32 v50, v36, v37
    v_cvt_pk_bf16_f32 v51, v38, v39
    v_fma_f32 v40, v40, s34, -v12
    v_fma_f32 v41, v41, s34, -v12
    v_fma_f32 v42, v42, s34, -v12
    v_fma_f32 v43, v43, s34, -v12
    v_fma_f32 v44, v44, s34, -v12
    v_fma_f32 v45, v45, s34, -v12
    v_fma_f32 v46, v46, s34, -v12
    v_fma_f32 v47, v47, s34, -v12
    v_exp_f32 v40, v40
    v_exp_f32 v41, v41
    v_exp_f32 v42, v42
    v_exp_f32 v43, v43
    v_exp_f32 v44, v44
    v_exp_f32 v45, v45
    v_exp_f32 v46, v46
    v_exp_f32 v47, v47
    v_cvt_pk_bf16_f32 v52, v40, v41
    v_cvt_pk_bf16_f32 v53, v42, v43
    v_cvt_pk_bf16_f32 v54, v44, v45
    v_cvt_pk_bf16_f32 v55, v46, v47
    v_add_f32 v13, v32, v33
    v_add_f32 v15, v40, v41
    v_add_f32 v13, v13, v34
    v_add_f32 v15, v15, v42
    v_add_f32 v13, v13, v35
    v_add_f32 v15, v15, v43
    v_add_f32 v13, v13, v36
    v_add_f32 v15, v15, v44
    v_add_f32 v13, v13, v37
    v_add_f32 v15, v15, v45
    v_add_f32 v13, v13, v38
    v_add_f32 v15, v15, v46
    v_add_f32 v13, v13, v39
    v_add_f32 v15, v15, v47
    v_add_f32 v13, v13, v15
    s_nop 1
    v_add_f32_dpp v13, v13, v13 quad_perm:[1,0,3,2] row_mask:0xf bank_mask:0xf
    v_mov_b32 v10, v13
    s_nop 1
    v_permlane16_swap_b32 v13, v10
    v_add_f32 v13, v13, v10
    v_mov_b32 v10, v13
    s_nop 1
    v_permlane32_swap_b32 v13, v10
    v_add_f32 v13, v13, v10
    v_mov_b32 v32, v2
    v_xor_b32 v33, 32, v2
    v_xor_b32 v34, 64, v2
    v_xor_b32 v35, 96, v2
    v_xor_b32 v36, 128, v2
    v_xor_b32 v37, 160, v2
    v_xor_b32 v38, 192, v2
    v_xor_b32 v39, 224, v2
    ds_read_b64_tr_b16 a[128:129], v32 offset:0
    ds_read_b64_tr_b16 a[130:131], v32 offset:4096
    ds_read_b64_tr_b16 a[132:133], v32 offset:2048
    ds_read_b64_tr_b16 a[134:135], v32 offset:6144
    ds_read_b64_tr_b16 a[144:145], v33 offset:0
    ds_read_b64_tr_b16 a[146:147], v33 offset:4096
    ds_read_b64_tr_b16 a[148:149], v33 offset:2048
    ds_read_b64_tr_b16 a[150:151], v33 offset:6144
    ds_read_b64_tr_b16 a[160:161], v34 offset:0
    ds_read_b64_tr_b16 a[162:163], v34 offset:4096
    ds_read_b64_tr_b16 a[164:165], v34 offset:2048
    ds_read_b64_tr_b16 a[166:167], v34 offset:6144
    ds_read_b64_tr_b16 a[176:177], v35 offset:0
    ds_read_b64_tr_b16 a[178:179], v35 offset:4096
    ds_read_b64_tr_b16 a[180:181], v35 offset:2048
    ds_read_b64_tr_b16 a[182:183], v35 offset:6144
    ds_read_b64_tr_b16 a[192:193], v36 offset:0
    ds_read_b64_tr_b16 a[194:195], v36 offset:4096
    ds_read_b64_tr_b16 a[196:197], v36 offset:2048
    ds_read_b64_tr_b16 a[198:199], v36 offset:6144
    ds_read_b64_tr_b16 a[208:209], v37 offset:0
    ds_read_b64_tr_b16 a[210:211], v37 offset:4096
    ds_read_b64_tr_b16 a[212:213], v37 offset:2048
    ds_read_b64_tr_b16 a[214:215], v37 offset:6144
    ds_read_b64_tr_b16 a[224:225], v38 offset:0
    ds_read_b64_tr_b16 a[226:227], v38 offset:4096
    ds_read_b64_tr_b16 a[228:229], v38 offset:2048
    ds_read_b64_tr_b16 a[230:231], v38 offset:6144
    ds_read_b64_tr_b16 a[240:241], v39 offset:0
    ds_read_b64_tr_b16 a[242:243], v39 offset:4096
    ds_read_b64_tr_b16 a[244:245], v39 offset:2048
    ds_read_b64_tr_b16 a[246:247], v39 offset:6144
    s_waitcnt lgkmcnt(0)
    v_smfmac_f32_16x16x64_bf16 v[64:67], v[48:51], a[128:135], v14
    v_smfmac_f32_16x16x64_bf16 v[68:71], v[48:51], a[144:151], v14
    v_smfmac_f32_16x16x64_bf16 v[72:75], v[48:51], a[160:167], v14
    v_smfmac_f32_16x16x64_bf16 v[76:79], v[48:51], a[176:183], v14
    v_smfmac_f32_16x16x64_bf16 v[16:19], v[48:51], a[192:199], v14
    v_smfmac_f32_16x16x64_bf16 v[20:23], v[48:51], a[208:215], v14
    v_smfmac_f32_16x16x64_bf16 v[24:27], v[48:51], a[224:231], v14
    v_smfmac_f32_16x16x64_bf16 v[28:31], v[48:51], a[240:247], v14
    s_waitcnt vmcnt(4)
    ds_read_b64_tr_b16 a[136:137], v32 offset:16384
    ds_read_b64_tr_b16 a[138:139], v32 offset:20480
    ds_read_b64_tr_b16 a[140:141], v32 offset:18432
    ds_read_b64_tr_b16 a[142:143], v32 offset:22528
    ds_read_b64_tr_b16 a[152:153], v33 offset:16384
    ds_read_b64_tr_b16 a[154:155], v33 offset:20480
    ds_read_b64_tr_b16 a[156:157], v33 offset:18432
    ds_read_b64_tr_b16 a[158:159], v33 offset:22528
    ds_read_b64_tr_b16 a[168:169], v34 offset:16384
    ds_read_b64_tr_b16 a[170:171], v34 offset:20480
    ds_read_b64_tr_b16 a[172:173], v34 offset:18432
    ds_read_b64_tr_b16 a[174:175], v34 offset:22528
    ds_read_b64_tr_b16 a[184:185], v35 offset:16384
    ds_read_b64_tr_b16 a[186:187], v35 offset:20480
    ds_read_b64_tr_b16 a[188:189], v35 offset:18432
    ds_read_b64_tr_b16 a[190:191], v35 offset:22528
    ds_read_b64_tr_b16 a[200:201], v36 offset:16384
    ds_read_b64_tr_b16 a[202:203], v36 offset:20480
    ds_read_b64_tr_b16 a[204:205], v36 offset:18432
    ds_read_b64_tr_b16 a[206:207], v36 offset:22528
    ds_read_b64_tr_b16 a[216:217], v37 offset:16384
    ds_read_b64_tr_b16 a[218:219], v37 offset:20480
    ds_read_b64_tr_b16 a[220:221], v37 offset:18432
    ds_read_b64_tr_b16 a[222:223], v37 offset:22528
    ds_read_b64_tr_b16 a[232:233], v38 offset:16384
    ds_read_b64_tr_b16 a[234:235], v38 offset:20480
    ds_read_b64_tr_b16 a[236:237], v38 offset:18432
    ds_read_b64_tr_b16 a[238:239], v38 offset:22528
    ds_read_b64_tr_b16 a[248:249], v39 offset:16384
    ds_read_b64_tr_b16 a[250:251], v39 offset:20480
    ds_read_b64_tr_b16 a[252:253], v39 offset:18432
    ds_read_b64_tr_b16 a[254:255], v39 offset:22528
    s_waitcnt lgkmcnt(0)
    v_smfmac_f32_16x16x64_bf16 v[64:67], v[52:55], a[136:143], v14
    v_smfmac_f32_16x16x64_bf16 v[68:71], v[52:55], a[152:159], v14
    v_smfmac_f32_16x16x64_bf16 v[72:75], v[52:55], a[168:175], v14
    v_smfmac_f32_16x16x64_bf16 v[76:79], v[52:55], a[184:191], v14
    v_smfmac_f32_16x16x64_bf16 v[16:19], v[52:55], a[200:207], v14
    v_smfmac_f32_16x16x64_bf16 v[20:23], v[52:55], a[216:223], v14
    v_smfmac_f32_16x16x64_bf16 v[24:27], v[52:55], a[232:239], v14
    v_smfmac_f32_16x16x64_bf16 v[28:31], v[52:55], a[248:255], v14
    v_and_b32 v9, 15, v0
    v_lshlrev_b32 v9, 2, v9
    s_lshl_b32 s41, s3, 9
    s_add_u32 s41, s41, 147456
    v_add_u32 v9, s41, v9
    s_lshl_b32 s41, s3, 3
    s_add_u32 s41, s41, 149504
    v_mov_b32 v10, s41
    s_mov_b32 exec_lo, 0xffff
    s_mov_b32 exec_hi, 0
    v_add_f32 v64, v64, v65
    v_add_f32 v68, v68, v69
    ds_write2_b32 v9, v64, v68 offset0:0 offset1:16
    v_add_f32 v72, v72, v73
    v_add_f32 v76, v76, v77
    ds_write2_b32 v9, v72, v76 offset0:32 offset1:48
    v_add_f32 v16, v16, v17
    v_add_f32 v20, v20, v21
    ds_write2_b32 v9, v16, v20 offset0:64 offset1:80
    v_add_f32 v24, v24, v25
    v_add_f32 v28, v28, v29
    ds_write2_b32 v9, v24, v28 offset0:96 offset1:112
    s_mov_b64 exec, 1
    ds_write_b64 v10, v[12:13]
    s_mov_b64 exec, -1
    s_waitcnt lgkmcnt(0)
    s_barrier
    s_cmp_lg_u32 s3, 0
    s_cbranch_scc1 Lw1_20
    v_lshlrev_b32 v9, 3, v0
    v_add_u32 v10, 147456, v9
    v_mov_b32 v11, 149504
    ds_read_b128 v[48:51], v11
    ds_read_b128 v[52:55], v11 offset:16
    ds_read_b64 v[32:33], v10 offset:0
    ds_read_b64 v[34:35], v10 offset:512
    ds_read_b64 v[36:37], v10 offset:1024
    ds_read_b64 v[38:39], v10 offset:1536
    s_lshl_b32 s41, s4, 15
    s_lshl_b32 s42, s5, 10
    s_add_u32 s41, s41, s42
    s_add_u32 s41, s41, 2097152
    v_add_u32 v9, s41, v9
    v_mov_b32 v10, s41
    s_waitcnt lgkmcnt(4)
    v_max3_f32 v56, v48, v50, v52
    v_mov_b32 v58, v1
    v_max_f32 v56, v56, v54
    v_mov_b32 v59, v1
    v_sub_f32 v48, v48, v56
    v_sub_f32 v50, v50, v56
    v_sub_f32 v52, v52, v56
    v_sub_f32 v54, v54, v56
    v_exp_f32 v48, v48
    v_exp_f32 v50, v50
    v_exp_f32 v52, v52
    v_exp_f32 v54, v54
    s_waitcnt lgkmcnt(0)
    v_mul_f32 v32, v48, v32
    v_mul_f32 v33, v48, v33
    v_mul_f32 v57, v48, v49
    v_fmac_f32 v32, v50, v34
    v_fmac_f32 v33, v50, v35
    v_fmac_f32 v57, v50, v51
    v_fmac_f32 v32, v52, v36
    v_fmac_f32 v33, v52, v37
    v_fmac_f32 v57, v52, v53
    v_fmac_f32 v32, v54, v38
    v_fmac_f32 v33, v54, v39
    v_fmac_f32 v57, v54, v55
    v_bfi_b32 v32, s35, v32, v1
    v_bfi_b32 v33, s35, v33, v1
    s_cmp_eq_u32 s13, 0
    s_cbranch_scc1 Lpg_22
    global_store_dwordx2 v9, v[32:33], s[10:11]
    s_mov_b64 exec, 1
    global_store_dwordx4 v10, v[56:59], s[10:11] offset:512
    s_mov_b64 exec, -1
    s_branch Lpe_23
Lpg_22:
    global_store_dwordx2 v9, v[32:33], s[10:11] sc1
    s_mov_b64 exec, 1
    global_store_dwordx4 v10, v[56:59], s[10:11] offset:512 sc1
    s_mov_b64 exec, -1
Lpe_23:
    v_lshrrev_b32 v9, 3, v0
    v_mul_u32_u24 v9, 8192, v9
    v_and_b32 v10, 7, v0
    v_lshl_add_u32 v9, v10, 4, v9
    s_lshl_b32 s41, s3, 15
    s_add_u32 s41, s41, 28672
    s_cmp_eq_u32 s3, 0
    s_cselect_b32 s41, 57344, s41
    s_mov_b32 m0, s41
    s_nop 0
    global_load_lds_dwordx4 v9, s[28:29] nt
    s_add_u32 s28, s28, 65536
    s_addc_u32 s29, s29, 0
    s_add_u32 s41, s41, 1024
    s_mov_b32 m0, s41
    s_nop 0
    global_load_lds_dwordx4 v9, s[28:29] nt
    s_add_u32 s28, s28, 65536
    s_addc_u32 s29, s29, 0
    s_add_u32 s41, s41, 1024
    s_mov_b32 m0, s41
    s_nop 0
    global_load_lds_dwordx4 v9, s[28:29] nt
    s_add_u32 s28, s28, 65536
    s_addc_u32 s29, s29, 0
    s_add_u32 s41, s41, 1024
    s_mov_b32 m0, s41
    s_nop 0
    global_load_lds_dwordx4 v9, s[28:29] nt
    s_add_u32 s42, s39, 0
    s_and_b32 s42, s42, 7
    s_lshl_b32 s42, s42, 12
    s_add_u32 s54, s20, s42
    s_addc_u32 s55, s21, 0
    global_load_dwordx4 v[128:131], v6, s[54:55] offset:0 nt
    global_load_dwordx4 v[132:135], v6, s[54:55] offset:64 nt
    global_load_dwordx4 v[136:139], v6, s[54:55] offset:128 nt
    global_load_dwordx4 v[140:143], v6, s[54:55] offset:192 nt
    s_add_u32 s42, s39, 1
    s_and_b32 s42, s42, 7
    s_lshl_b32 s42, s42, 12
    s_add_u32 s54, s20, s42
    s_addc_u32 s55, s21, 0
    global_load_dwordx4 v[144:147], v6, s[54:55] offset:0 nt
    global_load_dwordx4 v[148:151], v6, s[54:55] offset:64 nt
    global_load_dwordx4 v[152:155], v6, s[54:55] offset:128 nt
    global_load_dwordx4 v[156:159], v6, s[54:55] offset:192 nt
    s_add_u32 s42, s39, 2
    s_and_b32 s42, s42, 7
    s_lshl_b32 s42, s42, 12
    s_add_u32 s54, s20, s42
    s_addc_u32 s55, s21, 0
    global_load_dwordx4 v[160:163], v6, s[54:55] offset:0 nt
    global_load_dwordx4 v[164:167], v6, s[54:55] offset:64 nt
    global_load_dwordx4 v[168:171], v6, s[54:55] offset:128 nt
    global_load_dwordx4 v[172:175], v6, s[54:55] offset:192 nt
    s_add_u32 s42, s39, 3
    s_and_b32 s42, s42, 7
    s_lshl_b32 s42, s42, 12
    s_add_u32 s54, s20, s42
    s_addc_u32 s55, s21, 0
    global_load_dwordx4 v[176:179], v6, s[54:55] offset:0 nt
    global_load_dwordx4 v[180:183], v6, s[54:55] offset:64 nt
    global_load_dwordx4 v[184:187], v6, s[54:55] offset:128 nt
    global_load_dwordx4 v[188:191], v6, s[54:55] offset:192 nt
    s_lshr_b32 s41, s5, 2
    s_lshl_b32 s41, s41, 2
    s_add_u32 s41, s41, s3
    s_lshl_b32 s41, s41, 12
    s_lshl_b32 s42, s4, 2
    s_add_u32 s42, s42, s9
    s_lshl_b32 s42, s42, 7
    s_add_u32 s41, s41, s42
    s_add_u32 s41, s41, 524288
    v_and_b32 v14, 31, v0
    v_lshlrev_b32 v14, 2, v14
    v_add_u32 v14, s41, v14
    v_lshrrev_b32 v9, 5, v0
    v_lshlrev_b32 v9, 12, v9
    s_lshl_b32 s41, s4, 15
    s_lshl_b32 s42, s9, 13
    s_add_u32 s41, s41, s42
    s_add_u32 s41, s41, 2097152
    v_add_u32 v9, s41, v9
    v_and_b32 v10, 3, v0
    v_lshl_add_u32 v10, v10, 10, v9
    v_and_b32 v11, 31, v0
    v_lshl_add_u32 v9, v11, 4, v9
    v_lshlrev_b32 v11, 3, v11
    v_lshrrev_b32 v15, 5, v0
    v_mul_u32_u24 v15, 320, v15
    v_add_u32 v11, v11, v15
    v_add_u32 v11, 150528, v11
    s_mov_b32 s38, 0
Lpoll_24:
    global_load_dwordx4 v[32:35], v9, s[10:11] offset:0 sc1
    global_load_dwordx4 v[36:39], v9, s[10:11] offset:1024 sc1
    global_load_dwordx4 v[40:43], v9, s[10:11] offset:2048 sc1
    global_load_dwordx4 v[44:47], v9, s[10:11] offset:3072 sc1
    global_load_dwordx4 v[48:51], v10, s[10:11] offset:512 sc1
    s_waitcnt vmcnt(0)
    v_xor_b32 v32, s50, v32
    v_xor_b32 v33, s50, v33
    v_xor_b32 v34, s50, v34
    v_xor_b32 v35, s50, v35
    v_xor_b32 v36, s50, v36
    v_xor_b32 v37, s50, v37
    v_xor_b32 v38, s50, v38
    v_xor_b32 v39, s50, v39
    v_xor_b32 v40, s50, v40
    v_xor_b32 v41, s50, v41
    v_xor_b32 v42, s50, v42
    v_xor_b32 v43, s50, v43
    v_xor_b32 v44, s50, v44
    v_xor_b32 v45, s50, v45
    v_xor_b32 v46, s50, v46
    v_xor_b32 v47, s50, v47
    v_or3_b32 v15, v32, v33, v34
    v_or3_b32 v15, v15, v35, v36
    v_or3_b32 v15, v15, v37, v38
    v_or3_b32 v15, v15, v39, v40
    v_or3_b32 v15, v15, v41, v42
    v_or3_b32 v15, v15, v43, v44
    v_or3_b32 v15, v15, v45, v46
    v_or_b32 v15, v15, v47
    v_and_b32 v15, 0xff, v15
    v_bitop3_b32 v15, v50, v15, v1 bitop3:0xDE
    v_bitop3_b32 v15, v51, v15, v1 bitop3:0xDE
    v_cmp_eq_u32 vcc, 0, v15
    s_nop 0
    s_cmp_eq_u64 vcc, exec
    s_cbranch_scc1 Lpdone_25
Lpretry_26:
    s_add_u32 s38, s38, 1
    s_cmp_lt_u32 s38, 65536
    s_cbranch_scc1 Lpoll_24
Lpdone_25:
    v_max_f32_dpp v9, v48, v48 quad_perm:[1,0,3,2] row_mask:0xf bank_mask:0xf
    s_nop 1
    v_max_f32_dpp v9, v9, v9 quad_perm:[2,3,0,1] row_mask:0xf bank_mask:0xf
    v_sub_f32 v48, v48, v9
    v_exp_f32 v48, v48
    s_nop 0
    v_mul_f32 v49, v48, v49
    s_nop 1
    v_add_f32_dpp v9, v49, v49 quad_perm:[1,0,3,2] row_mask:0xf bank_mask:0xf
    s_nop 1
    v_add_f32_dpp v9, v9, v9 quad_perm:[2,3,0,1] row_mask:0xf bank_mask:0xf
    v_rcp_f32 v9, v9
    s_nop 0
    v_mul_f32 v48, v48, v9
    s_nop 1
    v_mul_f32_dpp v52, v48, v32 quad_perm:[0,0,0,0] row_mask:0xf bank_mask:0xf
    v_mul_f32_dpp v53, v48, v33 quad_perm:[0,0,0,0] row_mask:0xf bank_mask:0xf
    v_mul_f32_dpp v54, v48, v34 quad_perm:[0,0,0,0] row_mask:0xf bank_mask:0xf
    v_mul_f32_dpp v55, v48, v35 quad_perm:[0,0,0,0] row_mask:0xf bank_mask:0xf
    v_fmac_f32_dpp v52, v48, v36 quad_perm:[1,1,1,1] row_mask:0xf bank_mask:0xf
    v_fmac_f32_dpp v53, v48, v37 quad_perm:[1,1,1,1] row_mask:0xf bank_mask:0xf
    v_fmac_f32_dpp v54, v48, v38 quad_perm:[1,1,1,1] row_mask:0xf bank_mask:0xf
    v_fmac_f32_dpp v55, v48, v39 quad_perm:[1,1,1,1] row_mask:0xf bank_mask:0xf
    v_fmac_f32_dpp v52, v48, v40 quad_perm:[2,2,2,2] row_mask:0xf bank_mask:0xf
    v_fmac_f32_dpp v53, v48, v41 quad_perm:[2,2,2,2] row_mask:0xf bank_mask:0xf
    v_fmac_f32_dpp v54, v48, v42 quad_perm:[2,2,2,2] row_mask:0xf bank_mask:0xf
    v_fmac_f32_dpp v55, v48, v43 quad_perm:[2,2,2,2] row_mask:0xf bank_mask:0xf
    v_fmac_f32_dpp v52, v48, v44 quad_perm:[3,3,3,3] row_mask:0xf bank_mask:0xf
    v_fmac_f32_dpp v53, v48, v45 quad_perm:[3,3,3,3] row_mask:0xf bank_mask:0xf
    v_fmac_f32_dpp v54, v48, v46 quad_perm:[3,3,3,3] row_mask:0xf bank_mask:0xf
    v_fmac_f32_dpp v55, v48, v47 quad_perm:[3,3,3,3] row_mask:0xf bank_mask:0xf
    v_cvt_pk_bf16_f32 v52, v52, v53
    v_cvt_pk_bf16_f32 v53, v54, v55
    ds_write_b64 v11, v[52:53]
    s_branch Lwe_21
Lw1_20:
    s_lshr_b32 s41, s5, 2
    s_lshl_b32 s41, s41, 2
    s_add_u32 s41, s41, s3
    s_lshl_b32 s41, s41, 12
    s_lshl_b32 s42, s4, 2
    s_add_u32 s42, s42, s9
    s_lshl_b32 s42, s42, 7
    s_add_u32 s41, s41, s42
    s_add_u32 s41, s41, 524288
    v_and_b32 v14, 31, v0
    v_lshlrev_b32 v14, 2, v14
    v_add_u32 v14, s41, v14
    v_lshrrev_b32 v9, 3, v0
    v_mul_u32_u24 v9, 8192, v9
    v_and_b32 v10, 7, v0
    v_lshl_add_u32 v9, v10, 4, v9
    s_lshl_b32 s41, s3, 15
    s_add_u32 s41, s41, 28672
    s_cmp_eq_u32 s3, 0
    s_cselect_b32 s41, 57344, s41
    s_mov_b32 m0, s41
    s_nop 0
    global_load_lds_dwordx4 v9, s[28:29] nt
    s_add_u32 s28, s28, 65536
    s_addc_u32 s29, s29, 0
    s_add_u32 s41, s41, 1024
    s_mov_b32 m0, s41
    s_nop 0
    global_load_lds_dwordx4 v9, s[28:29] nt
    s_add_u32 s28, s28, 65536
    s_addc_u32 s29, s29, 0
    s_add_u32 s41, s41, 1024
    s_mov_b32 m0, s41
    s_nop 0
    global_load_lds_dwordx4 v9, s[28:29] nt
    s_add_u32 s28, s28, 65536
    s_addc_u32 s29, s29, 0
    s_add_u32 s41, s41, 1024
    s_mov_b32 m0, s41
    s_nop 0
    global_load_lds_dwordx4 v9, s[28:29] nt
    s_add_u32 s42, s39, 0
    s_and_b32 s42, s42, 7
    s_lshl_b32 s42, s42, 12
    s_add_u32 s54, s20, s42
    s_addc_u32 s55, s21, 0
    global_load_dwordx4 v[128:131], v6, s[54:55] offset:0 nt
    s_waitcnt vmcnt(8)
    global_load_dwordx4 v[132:135], v6, s[54:55] offset:64 nt
    s_waitcnt vmcnt(8)
    global_load_dwordx4 v[136:139], v6, s[54:55] offset:128 nt
    s_waitcnt vmcnt(8)
    global_load_dwordx4 v[140:143], v6, s[54:55] offset:192 nt
    s_add_u32 s42, s39, 1
    s_and_b32 s42, s42, 7
    s_lshl_b32 s42, s42, 12
    s_add_u32 s54, s20, s42
    s_addc_u32 s55, s21, 0
    s_waitcnt vmcnt(8)
    global_load_dwordx4 v[144:147], v6, s[54:55] offset:0 nt
    s_waitcnt vmcnt(8)
    global_load_dwordx4 v[148:151], v6, s[54:55] offset:64 nt
    s_waitcnt vmcnt(8)
    global_load_dwordx4 v[152:155], v6, s[54:55] offset:128 nt
    s_waitcnt vmcnt(8)
    global_load_dwordx4 v[156:159], v6, s[54:55] offset:192 nt
    s_add_u32 s42, s39, 2
    s_and_b32 s42, s42, 7
    s_lshl_b32 s42, s42, 12
    s_add_u32 s54, s20, s42
    s_addc_u32 s55, s21, 0
    s_waitcnt vmcnt(8)
    global_load_dwordx4 v[160:163], v6, s[54:55] offset:0 nt
    s_waitcnt vmcnt(8)
    global_load_dwordx4 v[164:167], v6, s[54:55] offset:64 nt
    s_waitcnt vmcnt(8)
    global_load_dwordx4 v[168:171], v6, s[54:55] offset:128 nt
    s_waitcnt vmcnt(8)
    global_load_dwordx4 v[172:175], v6, s[54:55] offset:192 nt
    s_add_u32 s42, s39, 3
    s_and_b32 s42, s42, 7
    s_lshl_b32 s42, s42, 12
    s_add_u32 s54, s20, s42
    s_addc_u32 s55, s21, 0
    s_waitcnt vmcnt(8)
    global_load_dwordx4 v[176:179], v6, s[54:55] offset:0 nt
    s_waitcnt vmcnt(8)
    global_load_dwordx4 v[180:183], v6, s[54:55] offset:64 nt
    s_waitcnt vmcnt(8)
    global_load_dwordx4 v[184:187], v6, s[54:55] offset:128 nt
    s_waitcnt vmcnt(8)
    global_load_dwordx4 v[188:191], v6, s[54:55] offset:192 nt
Lwe_21:
    s_waitcnt lgkmcnt(0)
    s_barrier
    v_lshrrev_b32 v12, 4, v0
    v_lshlrev_b32 v12, 3, v12
    v_bfe_u32 v15, v0, 2, 2
    v_add_u32 v12, v12, v15
    v_lshlrev_b32 v12, 7, v12
    v_and_b32 v15, 3, v0
    v_lshl_add_u32 v12, v15, 3, v12
    s_lshl_b32 s41, s3, 5
    s_add_u32 s41, s41, 131072
    v_add_u32 v12, s41, v12
    ds_read_b64_tr_b16 v[96:97], v12 offset:0
    ds_read_b64_tr_b16 v[98:99], v12 offset:512
    ds_read_b64_tr_b16 v[100:101], v12 offset:4096
    ds_read_b64_tr_b16 v[102:103], v12 offset:4608
    ds_read_b64_tr_b16 v[104:105], v12 offset:8192
    ds_read_b64_tr_b16 v[106:107], v12 offset:8704
    ds_read_b64_tr_b16 v[108:109], v12 offset:12288
    ds_read_b64_tr_b16 v[110:111], v12 offset:12800
    ds_read_b128 v[16:19], v4 offset:0
    ds_read_b128 v[20:23], v4 offset:64
    ds_read_b128 v[24:27], v4 offset:128
    ds_read_b128 v[28:31], v4 offset:192
    s_waitcnt lgkmcnt(3)
    v_mfma_f32_16x16x32_bf16 v[56:59], v[16:19], v[96:99], 0
    s_waitcnt lgkmcnt(2)
    v_mfma_f32_16x16x32_bf16 v[56:59], v[20:23], v[100:103], v[56:59]
    s_waitcnt lgkmcnt(1)
    v_mfma_f32_16x16x32_bf16 v[56:59], v[24:27], v[104:107], v[56:59]
    s_waitcnt lgkmcnt(0)
    v_mfma_f32_16x16x32_bf16 v[56:59], v[28:31], v[108:111], v[56:59]
    s_nop 7
    v_cndmask_b32 v32, v57, v56, s[46:47]
    v_bfi_b32 v32, s35, v32, v1
    s_mov_b32 exec_lo, 0xffffffff
    s_mov_b32 exec_hi, 0
    global_store_dword v14, v32, s[10:11] sc1
    s_mov_b64 exec, -1
    s_cmp_lg_u32 s3, 0
    s_cbranch_scc1 Lw1_27
    s_add_u32 s42, s39, 4
    s_and_b32 s42, s42, 7
    s_lshl_b32 s42, s42, 12
    s_add_u32 s54, s20, s42
    s_addc_u32 s55, s21, 0
    global_load_dwordx4 v[192:195], v6, s[54:55] offset:0 nt
    global_load_dwordx4 v[196:199], v6, s[54:55] offset:64 nt
    global_load_dwordx4 v[200:203], v6, s[54:55] offset:128 nt
    global_load_dwordx4 v[204:207], v6, s[54:55] offset:192 nt
    s_add_u32 s42, s39, 5
    s_and_b32 s42, s42, 7
    s_lshl_b32 s42, s42, 12
    s_add_u32 s54, s20, s42
    s_addc_u32 s55, s21, 0
    global_load_dwordx4 v[208:211], v6, s[54:55] offset:0 nt
    global_load_dwordx4 v[212:215], v6, s[54:55] offset:64 nt
    global_load_dwordx4 v[216:219], v6, s[54:55] offset:128 nt
    global_load_dwordx4 v[220:223], v6, s[54:55] offset:192 nt
    s_add_u32 s42, s39, 6
    s_and_b32 s42, s42, 7
    s_lshl_b32 s42, s42, 12
    s_add_u32 s54, s20, s42
    s_addc_u32 s55, s21, 0
    global_load_dwordx4 v[224:227], v6, s[54:55] offset:0 nt
    global_load_dwordx4 v[228:231], v6, s[54:55] offset:64 nt
    global_load_dwordx4 v[232:235], v6, s[54:55] offset:128 nt
    global_load_dwordx4 v[236:239], v6, s[54:55] offset:192 nt
    s_add_u32 s42, s39, 7
    s_and_b32 s42, s42, 7
    s_lshl_b32 s42, s42, 12
    s_add_u32 s54, s20, s42
    s_addc_u32 s55, s21, 0
    global_load_dwordx4 v[240:243], v6, s[54:55] offset:0 nt
    global_load_dwordx4 v[244:247], v6, s[54:55] offset:64 nt
    global_load_dwordx4 v[248:251], v6, s[54:55] offset:128 nt
    global_load_dwordx4 v[252:255], v6, s[54:55] offset:192 nt
    s_lshl_b32 s41, s5, 12
    s_add_u32 s41, s41, 524288
    v_lshlrev_b32 v13, 4, v0
    v_add_u32 v13, s41, v13
    v_and_b32 v9, 7, v0
    v_lshrrev_b32 v10, 4, v0
    v_lshl_add_u32 v9, v9, 2, v10
    v_lshlrev_b32 v9, 2, v9
    s_lshl_b32 s41, s4, 12
    s_lshl_b32 s42, s5, 7
    s_add_u32 s41, s41, s42
    s_add_u32 s41, s41, 98304
    v_add_u32 v9, s41, v9
    s_lshl_b32 s41, s4, 9
    s_lshl_b32 s42, s5, 4
    s_add_u32 s41, s41, s42
    s_add_u32 s41, s41, 266240
    v_bfe_u32 v10, v0, 2, 1
    v_lshlrev_b32 v10, 3, v10
    v_add_u32 v10, s41, v10
    s_lshl_b32 s41, s4, 12
    s_lshl_b32 s42, s45, 10
    s_add_u32 s41, s41, s42
    s_add_u32 s41, s41, 98304
    v_lshlrev_b32 v12, 4, v0
    v_add_u32 v12, s41, v12
    v_bfe_u32 v11, v0, 2, 1
    v_mul_u32_u24 v11, 320, v11
    v_lshrrev_b32 v15, 3, v0
    v_lshl_add_u32 v11, v15, 5, v11
    v_and_b32 v15, 3, v0
    v_lshl_add_u32 v11, v15, 3, v11
    v_add_u32 v11, 152064, v11
    s_mov_b32 s38, 0
    s_sleep 11
Lpoll_29:
    global_load_dwordx4 v[32:35], v13, s[10:11] offset:0 sc1
    global_load_dwordx4 v[36:39], v13, s[10:11] offset:1024 sc1
    global_load_dwordx4 v[40:43], v13, s[10:11] offset:2048 sc1
    global_load_dwordx4 v[44:47], v13, s[10:11] offset:3072 sc1
    s_waitcnt vmcnt(0)
    v_xor_b32 v32, s50, v32
    v_xor_b32 v33, s50, v33
    v_xor_b32 v34, s50, v34
    v_xor_b32 v35, s50, v35
    v_xor_b32 v36, s50, v36
    v_xor_b32 v37, s50, v37
    v_xor_b32 v38, s50, v38
    v_xor_b32 v39, s50, v39
    v_xor_b32 v40, s50, v40
    v_xor_b32 v41, s50, v41
    v_xor_b32 v42, s50, v42
    v_xor_b32 v43, s50, v43
    v_xor_b32 v44, s50, v44
    v_xor_b32 v45, s50, v45
    v_xor_b32 v46, s50, v46
    v_xor_b32 v47, s50, v47
    v_or3_b32 v15, v32, v33, v34
    v_or3_b32 v15, v15, v35, v36
    v_or3_b32 v15, v15, v37, v38
    v_or3_b32 v15, v15, v39, v40
    v_or3_b32 v15, v15, v41, v42
    v_or3_b32 v15, v15, v43, v44
    v_or3_b32 v15, v15, v45, v46
    v_or_b32 v15, v15, v47
    v_and_b32 v15, 0xff, v15
    v_cmp_eq_u32 vcc, 0, v15
    s_nop 0
    s_cmp_eq_u64 vcc, exec
    s_cbranch_scc1 Lpdone_30
Lpretry_31:
    s_add_u32 s38, s38, 1
    s_cmp_lt_u32 s38, 65536
    s_cbranch_scc1 Lpoll_29
Lpdone_30:
    v_add_f32 v32, v32, v36
    v_add_f32 v40, v40, v44
    v_add_f32 v33, v33, v37
    v_add_f32 v41, v41, v45
    v_add_f32 v34, v34, v38
    v_add_f32 v42, v42, v46
    v_add_f32 v35, v35, v39
    v_add_f32 v43, v43, v47
    v_add_f32 v32, v32, v40
    v_add_f32 v33, v33, v41
    v_add_f32 v34, v34, v42
    v_add_f32 v35, v35, v43
    v_add_f32_dpp v32, v32, v32 row_ror:8 row_mask:0xf bank_mask:0xf
    v_add_f32_dpp v33, v33, v33 row_ror:8 row_mask:0xf bank_mask:0xf
    v_add_f32_dpp v34, v34, v34 row_ror:8 row_mask:0xf bank_mask:0xf
    v_add_f32_dpp v35, v35, v35 row_ror:8 row_mask:0xf bank_mask:0xf
    v_permlane16_swap_b32 v32, v33
    s_nop 0
    v_permlane16_swap_b32 v34, v35
    v_add_f32 v32, v32, v33
    v_add_f32 v34, v34, v35
    s_nop 1
    v_permlane32_swap_b32 v32, v34
    v_add_f32 v32, v32, v34
    v_cvt_pk_bf16_f32 v32, v32, v32
    v_and_b32 v32, 0xffff0000, v32
    v_add_f32 v32, v3, v32
    v_cvt_pk_bf16_f32 v32, v32, v32
    v_and_b32 v3, 0xffff0000, v32
    v_bfi_b32 v32, s36, v3, v1
    s_mov_b32 exec_lo, 0xff00ff
    s_mov_b32 exec_hi, 0xff00ff
    s_cmp_eq_u32 s13, 0
    s_cbranch_scc1 Lpg_32
    global_store_dword v9, v32, s[10:11]
    s_branch Lpe_33
Lpg_32:
    global_store_dword v9, v32, s[10:11] sc1
Lpe_33:
    s_mov_b64 exec, -1
    v_mul_f32 v37, v3, v3
    v_add_f32_dpp v36, v3, v3 quad_perm:[1,0,3,2] row_mask:0xf bank_mask:0xf
    s_nop 0
    v_add_f32_dpp v37, v37, v37 quad_perm:[1,0,3,2] row_mask:0xf bank_mask:0xf
    v_add_f32_dpp v36, v36, v36 quad_perm:[2,3,0,1] row_mask:0xf bank_mask:0xf
    s_nop 0
    v_add_f32_dpp v37, v37, v37 quad_perm:[2,3,0,1] row_mask:0xf bank_mask:0xf
    v_mov_b32 v38, v36
    v_mov_b32 v39, v37
    s_nop 0
    v_permlane16_swap_b32 v36, v38
    v_permlane16_swap_b32 v37, v39
    v_add_f32 v36, v36, v38
    v_add_f32 v37, v37, v39
    v_mov_b32 v38, v36
    v_mov_b32 v39, v37
    s_nop 0
    v_permlane32_swap_b32 v36, v38
    v_permlane32_swap_b32 v37, v39
    v_add_f32 v36, v36, v38
    v_add_f32 v37, v37, v39
    v_bfi_b32 v36, s35, v36, v1
    v_bfi_b32 v37, s35, v37, v1
    s_mov_b64 exec, 17
    s_cmp_eq_u32 s13, 0
    s_cbranch_scc1 Lpg_34
    global_store_dwordx2 v10, v[36:37], s[10:11]
    s_branch Lpe_35
Lpg_34:
    global_store_dwordx2 v10, v[36:37], s[10:11] sc1
Lpe_35:
    s_mov_b64 exec, -1
    s_lshl_b32 s41, s4, 14
    s_lshl_b32 s44, s6, 12
    s_add_u32 s41, s41, s44
    s_add_u32 s41, s41, 1179648
    s_lshl_b32 s42, s45, 10
    s_add_u32 s41, s41, s42
    s_and_b32 s42, s5, 1
    s_lshl_b32 s42, s42, 2
    s_add_u32 s42, s42, s3
    s_lshl_b32 s43, s42, 7
    s_add_u32 s41, s41, s43
    v_and_b32 v14, 31, v0
    v_lshlrev_b32 v14, 2, v14
    v_add_u32 v14, s41, v14
    s_lshl_b32 s41, s4, 13
    s_lshl_b32 s44, s6, 11
    s_add_u32 s41, s41, s44
    s_add_u32 s41, s41, 393216
    s_lshl_b32 s43, s45, 9
    s_add_u32 s41, s41, s43
    s_lshl_b32 s42, s42, 6
    s_add_u32 s41, s41, s42
    v_and_b32 v13, 15, v0
    v_lshlrev_b32 v13, 2, v13
    v_add_u32 v13, s41, v13
    s_mov_b32 s38, 0
Lpoll_36:
    global_load_dwordx4 v[40:43], v12, s[10:11] sc1
    s_waitcnt vmcnt(0)
    v_xor_b32 v15, v40, v1
    v_bitop3_b32 v15, v41, v15, v1 bitop3:0xDE
    v_bitop3_b32 v15, v42, v15, v1 bitop3:0xDE
    v_bitop3_b32 v15, v43, v15, v1 bitop3:0xDE
    v_and_b32 v15, 0xffff, v15
    v_cmp_eq_u32 vcc, 0, v15
    s_nop 0
    s_cmp_eq_u64 vcc, exec
    s_cbranch_scc1 Lpdone_37
Lpretry_38:
    s_add_u32 s38, s38, 1
    s_cmp_lt_u32 s38, 65536
    s_cbranch_scc1 Lpoll_36
Lpdone_37:
    v_perm_b32 v40, v41, v40, s37
    v_perm_b32 v41, v43, v42, s37
    ds_write_b64 v11, v[40:41]
    s_branch Lwe_28
Lw1_27:
    s_lshl_b32 s41, s4, 14
    s_lshl_b32 s44, s6, 12
    s_add_u32 s41, s41, s44
    s_add_u32 s41, s41, 1179648
    s_lshl_b32 s42, s45, 10
    s_add_u32 s41, s41, s42
    s_and_b32 s42, s5, 1
    s_lshl_b32 s42, s42, 2
    s_add_u32 s42, s42, s3
    s_lshl_b32 s43, s42, 7
    s_add_u32 s41, s41, s43
    v_and_b32 v14, 31, v0
    v_lshlrev_b32 v14, 2, v14
    v_add_u32 v14, s41, v14
    s_lshl_b32 s41, s4, 13
    s_lshl_b32 s44, s6, 11
    s_add_u32 s41, s41, s44
    s_add_u32 s41, s41, 393216
    s_lshl_b32 s43, s45, 9
    s_add_u32 s41, s41, s43
    s_lshl_b32 s42, s42, 6
    s_add_u32 s41, s41, s42
    v_and_b32 v13, 15, v0
    v_lshlrev_b32 v13, 2, v13
    v_add_u32 v13, s41, v13
    s_add_u32 s42, s39, 4
    s_and_b32 s42, s42, 7
    s_lshl_b32 s42, s42, 12
    s_add_u32 s54, s20, s42
    s_addc_u32 s55, s21, 0
    s_waitcnt vmcnt(8)
    global_load_dwordx4 v[192:195], v6, s[54:55] offset:0 nt
    s_waitcnt vmcnt(8)
    global_load_dwordx4 v[196:199], v6, s[54:55] offset:64 nt
    s_waitcnt vmcnt(8)
    global_load_dwordx4 v[200:203], v6, s[54:55] offset:128 nt
    s_waitcnt vmcnt(8)
    global_load_dwordx4 v[204:207], v6, s[54:55] offset:192 nt
    s_add_u32 s42, s39, 5
    s_and_b32 s42, s42, 7
    s_lshl_b32 s42, s42, 12
    s_add_u32 s54, s20, s42
    s_addc_u32 s55, s21, 0
    s_waitcnt vmcnt(8)
    global_load_dwordx4 v[208:211], v6, s[54:55] offset:0 nt
    s_waitcnt vmcnt(8)
    global_load_dwordx4 v[212:215], v6, s[54:55] offset:64 nt
    s_waitcnt vmcnt(8)
    global_load_dwordx4 v[216:219], v6, s[54:55] offset:128 nt
    s_waitcnt vmcnt(8)
    global_load_dwordx4 v[220:223], v6, s[54:55] offset:192 nt
    s_add_u32 s42, s39, 6
    s_and_b32 s42, s42, 7
    s_lshl_b32 s42, s42, 12
    s_add_u32 s54, s20, s42
    s_addc_u32 s55, s21, 0
    s_waitcnt vmcnt(8)
    global_load_dwordx4 v[224:227], v6, s[54:55] offset:0 nt
    s_waitcnt vmcnt(8)
    global_load_dwordx4 v[228:231], v6, s[54:55] offset:64 nt
    s_waitcnt vmcnt(8)
    global_load_dwordx4 v[232:235], v6, s[54:55] offset:128 nt
    s_waitcnt vmcnt(8)
    global_load_dwordx4 v[236:239], v6, s[54:55] offset:192 nt
    s_add_u32 s42, s39, 7
    s_and_b32 s42, s42, 7
    s_lshl_b32 s42, s42, 12
    s_add_u32 s54, s20, s42
    s_addc_u32 s55, s21, 0
    s_waitcnt vmcnt(8)
    global_load_dwordx4 v[240:243], v6, s[54:55] offset:0 nt
    s_waitcnt vmcnt(8)
    global_load_dwordx4 v[244:247], v6, s[54:55] offset:64 nt
    s_waitcnt vmcnt(8)
    global_load_dwordx4 v[248:251], v6, s[54:55] offset:128 nt
    s_waitcnt vmcnt(8)
    global_load_dwordx4 v[252:255], v6, s[54:55] offset:192 nt
    s_add_u32 s41, s3, -1
    s_lshl_b32 s42, s41, 6
    s_and_b32 s42, s42, 128
    v_xor_b32 v9, s42, v7
    v_xor_b32 v10, s42, v8
    s_add_u32 s42, s41, s40
    s_and_b32 s42, s42, 7
    s_lshl_b32 s42, s42, 12
    s_add_u32 s54, s52, s42
    s_addc_u32 s55, s53, 0
    s_lshl_b32 s41, s41, 12
    s_mov_b32 m0, s41
    s_waitcnt vmcnt(8)
    global_load_lds_dwordx4 v9, s[54:55] offset:0 nt
    s_waitcnt vmcnt(8)
    global_load_lds_dwordx4 v10, s[54:55] offset:1024 nt
    s_waitcnt vmcnt(8)
    global_load_lds_dwordx4 v9, s[54:55] offset:2048 nt
    s_waitcnt vmcnt(8)
    global_load_lds_dwordx4 v10, s[54:55] offset:3072 nt
    s_add_u32 s41, s3, 2
    s_lshl_b32 s42, s41, 6
    s_and_b32 s42, s42, 128
    v_xor_b32 v9, s42, v7
    v_xor_b32 v10, s42, v8
    s_add_u32 s42, s41, s40
    s_and_b32 s42, s42, 7
    s_lshl_b32 s42, s42, 12
    s_add_u32 s54, s52, s42
    s_addc_u32 s55, s53, 0
    s_lshl_b32 s41, s41, 12
    s_mov_b32 m0, s41
    s_waitcnt vmcnt(8)
    global_load_lds_dwordx4 v9, s[54:55] offset:0 nt
    s_waitcnt vmcnt(8)
    global_load_lds_dwordx4 v10, s[54:55] offset:1024 nt
    s_waitcnt vmcnt(8)
    global_load_lds_dwordx4 v9, s[54:55] offset:2048 nt
    s_waitcnt vmcnt(8)
    global_load_lds_dwordx4 v10, s[54:55] offset:3072 nt
    s_add_u32 s41, s3, 5
    s_cmp_ge_u32 s41, 8
    s_cbranch_scc1 Lsk_39
    s_lshl_b32 s42, s41, 6
    s_and_b32 s42, s42, 128
    v_xor_b32 v9, s42, v7
    v_xor_b32 v10, s42, v8
    s_add_u32 s42, s41, s40
    s_and_b32 s42, s42, 7
    s_lshl_b32 s42, s42, 12
    s_add_u32 s54, s52, s42
    s_addc_u32 s55, s53, 0
    s_lshl_b32 s41, s41, 12
    s_mov_b32 m0, s41
    s_nop 0
    global_load_lds_dwordx4 v9, s[54:55] offset:0 nt
    global_load_lds_dwordx4 v10, s[54:55] offset:1024 nt
    global_load_lds_dwordx4 v9, s[54:55] offset:2048 nt
    global_load_lds_dwordx4 v10, s[54:55] offset:3072 nt
Lsk_39:
    s_add_u32 s42, s39, 0
    s_and_b32 s42, s42, 7
    s_lshl_b32 s42, s42, 12
    s_add_u32 s54, s22, s42
    s_addc_u32 s55, s23, 0
    s_lshl_b32 s41, s3, 15
    s_add_u32 s41, s41, 0
    s_mov_b32 m0, s41
    s_waitcnt vmcnt(8)
    global_load_lds_dwordx4 v7, s[54:55] offset:0 nt
    s_waitcnt vmcnt(8)
    global_load_lds_dwordx4 v8, s[54:55] offset:1024 nt
    s_waitcnt vmcnt(8)
    global_load_lds_dwordx4 v7, s[54:55] offset:2048 nt
    s_waitcnt vmcnt(8)
    global_load_lds_dwordx4 v8, s[54:55] offset:3072 nt
    s_add_u32 s42, s39, 1
    s_and_b32 s42, s42, 7
    s_lshl_b32 s42, s42, 12
    s_add_u32 s54, s22, s42
    s_addc_u32 s55, s23, 0
    s_lshl_b32 s41, s3, 15
    s_add_u32 s41, s41, 4096
    s_mov_b32 m0, s41
    s_waitcnt vmcnt(8)
    global_load_lds_dwordx4 v7, s[54:55] offset:0 nt
    s_waitcnt vmcnt(8)
    global_load_lds_dwordx4 v8, s[54:55] offset:1024 nt
    s_waitcnt vmcnt(8)
    global_load_lds_dwordx4 v7, s[54:55] offset:2048 nt
    s_waitcnt vmcnt(8)
    global_load_lds_dwordx4 v8, s[54:55] offset:3072 nt
    s_add_u32 s42, s39, 2
    s_and_b32 s42, s42, 7
    s_lshl_b32 s42, s42, 12
    s_add_u32 s54, s22, s42
    s_addc_u32 s55, s23, 0
    s_lshl_b32 s41, s3, 15
    s_add_u32 s41, s41, 8192
    s_mov_b32 m0, s41
    s_waitcnt vmcnt(8)
    global_load_lds_dwordx4 v8, s[54:55] offset:0 nt
    s_waitcnt vmcnt(8)
    global_load_lds_dwordx4 v7, s[54:55] offset:1024 nt
    s_waitcnt vmcnt(8)
    global_load_lds_dwordx4 v8, s[54:55] offset:2048 nt
    s_waitcnt vmcnt(8)
    global_load_lds_dwordx4 v7, s[54:55] offset:3072 nt
Lwe_28:
    s_waitcnt lgkmcnt(0)
    s_barrier
    v_lshrrev_b32 v12, 4, v0
    v_lshlrev_b32 v12, 3, v12
    v_bfe_u32 v15, v0, 2, 2
    v_add_u32 v12, v12, v15
    v_lshlrev_b32 v12, 7, v12
    v_and_b32 v15, 3, v0
    v_lshl_add_u32 v12, v15, 3, v12
    s_lshl_b32 s41, s3, 5
    s_add_u32 s41, s41, 0
    v_add_u32 v12, s41, v12
    v_add_u32 v11, 0x10000, v12
    ds_read_b64_tr_b16 v[112:113], v12 offset:57344
    ds_read_b64_tr_b16 v[114:115], v12 offset:57856
    ds_read_b64_tr_b16 v[116:117], v12 offset:61440
    ds_read_b64_tr_b16 v[118:119], v12 offset:61952
    ds_read_b64_tr_b16 v[120:121], v11 offset:28672
    ds_read_b64_tr_b16 v[122:123], v11 offset:29184
    ds_read_b64_tr_b16 v[124:125], v11 offset:61440
    ds_read_b64_tr_b16 v[126:127], v11 offset:61952
    ds_read_b128 v[16:19], v4 offset:1536
    ds_read_b128 v[20:23], v4 offset:1600
    ds_read_b128 v[24:27], v4 offset:1664
    ds_read_b128 v[28:31], v4 offset:1728
    s_waitcnt lgkmcnt(3)
    v_mfma_f32_16x16x32_bf16 v[56:59], v[16:19], v[112:115], 0
    s_waitcnt lgkmcnt(2)
    v_mfma_f32_16x16x32_bf16 v[56:59], v[20:23], v[116:119], v[56:59]
    s_waitcnt lgkmcnt(1)
    v_mfma_f32_16x16x32_bf16 v[56:59], v[24:27], v[120:123], v[56:59]
    s_waitcnt lgkmcnt(0)
    v_mfma_f32_16x16x32_bf16 v[56:59], v[28:31], v[124:127], v[56:59]
    s_nop 7
    v_cndmask_b32 v32, v57, v56, s[46:47]
    v_bfi_b32 v32, s35, v32, v1
    v_bfi_b32 v58, s35, v58, v1
    s_cmp_eq_u32 s13, 0
    s_cbranch_scc1 Lpg_40
    s_mov_b32 exec_lo, 0xffffffff
    s_mov_b32 exec_hi, 0
    global_store_dword v14, v32, s[10:11]
    s_mov_b32 exec_lo, 0xffff
    s_mov_b32 exec_hi, 0
    global_store_dword v13, v58, s[10:11]
    s_mov_b64 exec, -1
    s_branch Lpe_41
Lpg_40:
    s_mov_b32 exec_lo, 0xffffffff
    s_mov_b32 exec_hi, 0
    global_store_dword v14, v32, s[10:11] sc1
    s_mov_b32 exec_lo, 0xffff
    s_mov_b32 exec_hi, 0
    global_store_dword v13, v58, s[10:11] sc1
    s_mov_b64 exec, -1
Lpe_41:
    s_cmp_lg_u32 s3, 0
    s_cbranch_scc1 Lw1_42
    s_lshl_b32 s41, s4, 9
    s_add_u32 s41, s41, 266240
    v_and_b32 v12, 31, v0
    v_lshlrev_b32 v12, 4, v12
    v_add_u32 v12, s41, v12
    s_lshl_b32 s41, s4, 14
    s_lshl_b32 s44, s6, 12
    s_add_u32 s41, s41, s44
    s_add_u32 s41, s41, 1179648
    s_lshl_b32 s42, s7, 6
    s_add_u32 s41, s41, s42
    v_lshrrev_b32 v9, 3, v0
    v_lshlrev_b32 v9, 7, v9
    v_and_b32 v11, 7, v0
    v_lshl_add_u32 v9, v11, 3, v9
    v_add_u32 v9, s41, v9
    s_lshl_b32 s41, s4, 13
    s_lshl_b32 s44, s6, 11
    s_add_u32 s41, s41, s44
    s_add_u32 s41, s41, 393216
    v_lshlrev_b32 v10, 3, v0
    v_add_u32 v10, s41, v10
    v_lshlrev_b32 v11, 2, v0
    v_add_u32 v11, 153600, v11
    global_load_dwordx4 v[52:55], v12, s[10:11] sc1
    global_load_dwordx2 v[32:33], v9, s[10:11] offset:0 sc1
    global_load_dwordx2 v[34:35], v9, s[10:11] offset:1024 sc1
    global_load_dwordx2 v[36:37], v9, s[10:11] offset:2048 sc1
    global_load_dwordx2 v[38:39], v9, s[10:11] offset:3072 sc1
    global_load_dwordx2 v[40:41], v10, s[10:11] offset:0 sc1
    global_load_dwordx2 v[42:43], v10, s[10:11] offset:512 sc1
    global_load_dwordx2 v[44:45], v10, s[10:11] offset:1024 sc1
    global_load_dwordx2 v[46:47], v10, s[10:11] offset:1536 sc1
    s_waitcnt vmcnt(8)
    v_xor_b32 v52, s50, v52
    v_xor_b32 v53, s50, v53
    v_xor_b32 v54, s50, v54
    v_xor_b32 v55, s50, v55
    v_or3_b32 v15, v52, v53, v54
    v_or_b32 v15, v15, v55
    v_and_b32 v15, 0xff, v15
    v_cmp_eq_u32 vcc, 0, v15
    s_nop 0
    s_cmp_eq_u64 vcc, exec
    s_cbranch_scc1 Lok_44
    s_mov_b32 s38, 0
Lpoll_45:
    global_load_dwordx4 v[52:55], v12, s[10:11] sc1
    s_waitcnt vmcnt(0)
    v_xor_b32 v52, s50, v52
    v_xor_b32 v53, s50, v53
    v_xor_b32 v54, s50, v54
    v_xor_b32 v55, s50, v55
    v_or3_b32 v15, v52, v53, v54
    v_or_b32 v15, v15, v55
    v_and_b32 v15, 0xff, v15
    v_cmp_eq_u32 vcc, 0, v15
    s_nop 0
    s_cmp_eq_u64 vcc, exec
    s_cbranch_scc1 Lpdone_46
Lpretry_47:
    s_add_u32 s38, s38, 1
    s_cmp_lt_u32 s38, 65536
    s_cbranch_scc1 Lpoll_45
Lpdone_46:
Lok_44:
    s_cmp_eq_u32 s7, 0
    s_cbranch_scc1 Lb0_48
    v_mov_b32 v52, v54
    v_mov_b32 v53, v55
Lb0_48:
    s_nop 0
    v_add_f32_dpp v52, v52, v52 row_ror:8 row_mask:0xf bank_mask:0xf
    v_add_f32_dpp v53, v53, v53 row_ror:8 row_mask:0xf bank_mask:0xf
    s_nop 0
    v_add_f32_dpp v52, v52, v52 row_ror:4 row_mask:0xf bank_mask:0xf
    v_add_f32_dpp v53, v53, v53 row_ror:4 row_mask:0xf bank_mask:0xf
    s_nop 0
    v_add_f32_dpp v52, v52, v52 row_ror:2 row_mask:0xf bank_mask:0xf
    v_add_f32_dpp v53, v53, v53 row_ror:2 row_mask:0xf bank_mask:0xf
    s_nop 0
    v_add_f32_dpp v52, v52, v52 row_ror:1 row_mask:0xf bank_mask:0xf
    v_add_f32_dpp v53, v53, v53 row_ror:1 row_mask:0xf bank_mask:0xf
    v_mov_b32 v54, v52
    v_mov_b32 v55, v53
    s_nop 0
    v_permlane16_swap_b32 v52, v54
    v_permlane16_swap_b32 v53, v55
    v_add_f32 v52, v52, v54
    v_add_f32 v53, v53, v55
    v_mul_f32 v76, 0x3b000000, v52
    v_mul_f32 v53, 0x3b000000, v53
    v_fma_f32 v53, -v76, v76, v53
    v_max_f32 v53, 0, v53
    v_add_f32 v53, 0x3727c5ac, v53
    v_rsq_f32 v77, v53
    s_waitcnt vmcnt(0)
    v_xor_b32 v32, s50, v32
    v_xor_b32 v33, s50, v33
    v_xor_b32 v34, s50, v34
    v_xor_b32 v35, s50, v35
    v_xor_b32 v36, s50, v36
    v_xor_b32 v37, s50, v37
    v_xor_b32 v38, s50, v38
    v_xor_b32 v39, s50, v39
    v_xor_b32 v40, s50, v40
    v_xor_b32 v41, s50, v41
    v_xor_b32 v42, s50, v42
    v_xor_b32 v43, s50, v43
    v_xor_b32 v44, s50, v44
    v_xor_b32 v45, s50, v45
    v_xor_b32 v46, s50, v46
    v_xor_b32 v47, s50, v47
    v_or3_b32 v15, v32, v33, v34
    v_or3_b32 v15, v15, v35, v36
    v_or3_b32 v15, v15, v37, v38
    v_or3_b32 v15, v15, v39, v40
    v_or3_b32 v15, v15, v41, v42
    v_or3_b32 v15, v15, v43, v44
    v_or3_b32 v15, v15, v45, v46
    v_or_b32 v15, v15, v47
    v_and_b32 v15, 0xff, v15
    v_cmp_eq_u32 vcc, 0, v15
    s_nop 0
    s_cmp_eq_u64 vcc, exec
    s_cbranch_scc1 Lok_49
    s_mov_b32 s38, 0
Lpoll_50:
    global_load_dwordx2 v[32:33], v9, s[10:11] offset:0 sc1
    global_load_dwordx2 v[34:35], v9, s[10:11] offset:1024 sc1
    global_load_dwordx2 v[36:37], v9, s[10:11] offset:2048 sc1
    global_load_dwordx2 v[38:39], v9, s[10:11] offset:3072 sc1
    global_load_dwordx2 v[40:41], v10, s[10:11] offset:0 sc1
    global_load_dwordx2 v[42:43], v10, s[10:11] offset:512 sc1
    global_load_dwordx2 v[44:45], v10, s[10:11] offset:1024 sc1
    global_load_dwordx2 v[46:47], v10, s[10:11] offset:1536 sc1
    s_waitcnt vmcnt(0)
    v_xor_b32 v32, s50, v32
    v_xor_b32 v33, s50, v33
    v_xor_b32 v34, s50, v34
    v_xor_b32 v35, s50, v35
    v_xor_b32 v36, s50, v36
    v_xor_b32 v37, s50, v37
    v_xor_b32 v38, s50, v38
    v_xor_b32 v39, s50, v39
    v_xor_b32 v40, s50, v40
    v_xor_b32 v41, s50, v41
    v_xor_b32 v42, s50, v42
    v_xor_b32 v43, s50, v43
    v_xor_b32 v44, s50, v44
    v_xor_b32 v45, s50, v45
    v_xor_b32 v46, s50, v46
    v_xor_b32 v47, s50, v47
    v_or3_b32 v15, v32, v33, v34
    v_or3_b32 v15, v15, v35, v36
    v_or3_b32 v15, v15, v37, v38
    v_or3_b32 v15, v15, v39, v40
    v_or3_b32 v15, v15, v41, v42
    v_or3_b32 v15, v15, v43, v44
    v_or3_b32 v15, v15, v45, v46
    v_or_b32 v15, v15, v47
    v_and_b32 v15, 0xff, v15
    v_cmp_eq_u32 vcc, 0, v15
    s_nop 0
    s_cmp_eq_u64 vcc, exec
    s_cbranch_scc1 Lpdone_51
Lpretry_52:
    s_add_u32 s38, s38, 1
    s_cmp_lt_u32 s38, 65536
    s_cbranch_scc1 Lpoll_50
Lpdone_51:
Lok_49:
    v_add_f32 v32, v32, v34
    v_add_f32 v36, v36, v38
    v_add_f32 v33, v33, v35
    v_add_f32 v37, v37, v39
    v_add_f32 v32, v32, v36
    v_add_f32 v33, v33, v37
    v_add_f32 v40, v40, v42
    v_add_f32 v44, v44, v46
    v_add_f32 v41, v41, v43
    v_add_f32 v45, v45, v47
    v_add_f32 v40, v40, v44
    v_add_f32 v41, v41, v45
    v_lshlrev_b32 v10, 3, v0
    v_add_u32 v10, 154368, v10
    ds_write_b64 v10, v[40:41]
    v_fma_f32 v32, -v76, v40, v32
    v_fma_f32 v33, -v76, v41, v33
    v_mul_f32 v32, v77, v32
    v_mul_f32 v33, v77, v33
    v_cvt_pk_bf16_f32 v32, v32, v33
    ds_write_b32 v11, v32
    s_branch Lwe_43
Lw1_42:
    s_add_u32 s42, s39, 3
    s_and_b32 s42, s42, 7
    s_lshl_b32 s42, s42, 12
    s_add_u32 s54, s22, s42
    s_addc_u32 s55, s23, 0
    s_lshl_b32 s41, s3, 15
    s_add_u32 s41, s41, 12288
    s_mov_b32 m0, s41
    s_waitcnt vmcnt(8)
    global_load_lds_dwordx4 v8, s[54:55] offset:0 nt
    s_waitcnt vmcnt(8)
    global_load_lds_dwordx4 v7, s[54:55] offset:1024 nt
    s_waitcnt vmcnt(8)
    global_load_lds_dwordx4 v8, s[54:55] offset:2048 nt
    s_waitcnt vmcnt(8)
    global_load_lds_dwordx4 v7, s[54:55] offset:3072 nt
    s_add_u32 s42, s39, 4
    s_and_b32 s42, s42, 7
    s_lshl_b32 s42, s42, 12
    s_add_u32 s54, s22, s42
    s_addc_u32 s55, s23, 0
    s_lshl_b32 s41, s3, 15
    s_add_u32 s41, s41, 16384
    s_mov_b32 m0, s41
    s_waitcnt vmcnt(8)
    global_load_lds_dwordx4 v7, s[54:55] offset:0 nt
    s_waitcnt vmcnt(8)
    global_load_lds_dwordx4 v8, s[54:55] offset:1024 nt
    s_waitcnt vmcnt(8)
    global_load_lds_dwordx4 v7, s[54:55] offset:2048 nt
    s_waitcnt vmcnt(8)
    global_load_lds_dwordx4 v8, s[54:55] offset:3072 nt
    s_add_u32 s42, s39, 5
    s_and_b32 s42, s42, 7
    s_lshl_b32 s42, s42, 12
    s_add_u32 s54, s22, s42
    s_addc_u32 s55, s23, 0
    s_lshl_b32 s41, s3, 15
    s_add_u32 s41, s41, 20480
    s_mov_b32 m0, s41
    s_waitcnt vmcnt(8)
    global_load_lds_dwordx4 v7, s[54:55] offset:0 nt
    s_waitcnt vmcnt(8)
    global_load_lds_dwordx4 v8, s[54:55] offset:1024 nt
    s_waitcnt vmcnt(8)
    global_load_lds_dwordx4 v7, s[54:55] offset:2048 nt
    s_waitcnt vmcnt(8)
    global_load_lds_dwordx4 v8, s[54:55] offset:3072 nt
Lwe_43:
    s_waitcnt lgkmcnt(0)
    s_barrier
    ds_read_b128 v[16:19], v5 offset:0
    ds_read_b128 v[20:23], v5 offset:64
    ds_read_b128 v[24:27], v5 offset:128
    ds_read_b128 v[28:31], v5 offset:192
    s_waitcnt lgkmcnt(0)
    s_cmp_lg_u32 s3, 0
    s_cbranch_scc1 Lw1_53
    s_mov_b32 m0, 155648
    v_mul_u32_u24 v9, 52, v0
    v_lshrrev_b32 v9, 8, v9
    v_mul_u32_u24 v10, 5, v9
    v_sub_u32 v10, v0, v10
    v_lshlrev_b32 v10, 7, v10
    v_lshlrev_b32 v9, 18, v9
    v_add_u32 v9, v9, v10
    s_lshl_b32 s41, s4, 15
    s_lshl_b32 s42, s5, 10
    s_add_u32 s41, s41, s42
    s_add_u32 s41, s41, 2359296
    v_add_u32 v9, s41, v9
    s_lshl_b32 s41, s4, 14
    s_lshl_b32 s44, s6, 12
    s_add_u32 s41, s41, s44
    s_add_u32 s41, s41, 1310720
    s_lshl_b32 s42, s45, 10
    s_add_u32 s41, s41, s42
    s_and_b32 s42, s5, 1
    s_lshl_b32 s42, s42, 9
    s_add_u32 s41, s41, s42
    v_and_b32 v10, 3, v0
    v_lshlrev_b32 v10, 7, v10
    v_bfe_u32 v11, v0, 2, 1
    v_lshlrev_b32 v11, 17, v11
    v_add_u32 v10, v10, v11
    v_add_u32 v10, s41, v10
    v_cmp_gt_u32 vcc, 16, v0
    s_nop 1
    v_cndmask_b32 v9, v10, v9, vcc
    s_lshl_b32 s41, s4, 12
    s_lshl_b32 s42, s5, 7
    s_add_u32 s41, s41, s42
    s_add_u32 s41, s41, 131072
    v_and_b32 v11, 1, v0
    v_lshlrev_b32 v10, 15, v11
    v_add_u32 v10, s41, v10
    v_cmp_gt_u32 vcc, 24, v0
    s_nop 1
    v_cndmask_b32 v9, v10, v9, vcc
    s_lshl_b32 s41, s4, 9
    s_lshl_b32 s42, s5, 4
    s_add_u32 s41, s41, s42
    s_add_u32 s41, s41, 270336
    v_lshlrev_b32 v10, 12, v11
    v_add_u32 v10, s41, v10
    v_cmp_gt_u32 vcc, 26, v0
    s_nop 1
    v_cndmask_b32 v9, v10, v9, vcc
    s_mov_b32 exec_lo, 0xfff7fff
    s_mov_b32 exec_hi, 0
    global_load_lds_dword v9, s[10:11] sc1
    s_mov_b64 exec, -1
    v_lshrrev_b32 v10, 3, v0
    v_mul_u32_u24 v10, 1024, v10
    v_and_b32 v11, 7, v0
    v_lshl_add_u32 v10, v11, 4, v10
    s_lshl_b32 s41, s3, 12
    s_add_u32 s41, s41, 131072
    s_mov_b32 m0, s41
    s_nop 0
    global_load_lds_dwordx4 v10, s[30:31] nt
    s_add_u32 s30, s30, 8192
    s_addc_u32 s31, s31, 0
    s_add_u32 s41, s41, 1024
    s_mov_b32 m0, s41
    s_nop 0
    global_load_lds_dwordx4 v10, s[30:31] nt
    s_add_u32 s30, s30, 8192
    s_addc_u32 s31, s31, 0
    s_add_u32 s41, s41, 1024
    s_mov_b32 m0, s41
    s_nop 0
    global_load_lds_dwordx4 v10, s[30:31] nt
    s_add_u32 s30, s30, 8192
    s_addc_u32 s31, s31, 0
    s_add_u32 s41, s41, 1024
    s_mov_b32 m0, s41
    s_nop 0
    global_load_lds_dwordx4 v10, s[30:31] nt
    v_mfma_f32_16x16x32_bf16 v[32:35], v[128:131], v[16:19], 0
    v_mfma_f32_16x16x32_bf16 v[32:35], v[132:135], v[20:23], v[32:35]
    v_mfma_f32_16x16x32_bf16 v[32:35], v[136:139], v[24:27], v[32:35]
    v_mfma_f32_16x16x32_bf16 v[32:35], v[140:143], v[28:31], v[32:35]
    v_mov_b64 v[64:65], 0
    v_mfma_f32_16x16x32_bf16 v[36:39], v[144:147], v[16:19], 0
    v_mfma_f32_16x16x32_bf16 v[36:39], v[148:151], v[20:23], v[36:39]
    v_mfma_f32_16x16x32_bf16 v[36:39], v[152:155], v[24:27], v[36:39]
    v_mfma_f32_16x16x32_bf16 v[36:39], v[156:159], v[28:31], v[36:39]
    v_mov_b64 v[68:69], 0
    v_mfma_f32_16x16x32_bf16 v[40:43], v[160:163], v[16:19], 0
    v_mfma_f32_16x16x32_bf16 v[40:43], v[164:167], v[20:23], v[40:43]
    v_mfma_f32_16x16x32_bf16 v[40:43], v[168:171], v[24:27], v[40:43]
    v_mfma_f32_16x16x32_bf16 v[40:43], v[172:175], v[28:31], v[40:43]
    v_cndmask_b32 v32, v32, v34, s[56:57]
    v_cndmask_b32 v33, v33, v35, s[56:57]
    v_max_f32 v9, v32, v33
    v_mov_b64 v[72:73], 0
    v_mfma_f32_16x16x32_bf16 v[44:47], v[176:179], v[16:19], 0
    v_mfma_f32_16x16x32_bf16 v[44:47], v[180:183], v[20:23], v[44:47]
    v_mfma_f32_16x16x32_bf16 v[44:47], v[184:187], v[24:27], v[44:47]
    v_mfma_f32_16x16x32_bf16 v[44:47], v[188:191], v[28:31], v[44:47]
    v_cndmask_b32 v34, v36, v38, s[56:57]
    v_cndmask_b32 v35, v37, v39, s[56:57]
    v_max3_f32 v9, v9, v34, v35
    v_mov_b64 v[76:77], 0
    v_mfma_f32_16x16x32_bf16 v[48:51], v[192:195], v[16:19], 0
    v_mfma_f32_16x16x32_bf16 v[48:51], v[196:199], v[20:23], v[48:51]
    v_mfma_f32_16x16x32_bf16 v[48:51], v[200:203], v[24:27], v[48:51]
    v_mfma_f32_16x16x32_bf16 v[48:51], v[204:207], v[28:31], v[48:51]
    v_cndmask_b32 v36, v40, v42, s[56:57]
    v_cndmask_b32 v37, v41, v43, s[56:57]
    v_max3_f32 v9, v9, v36, v37
    v_mfma_f32_16x16x32_bf16 v[52:55], v[208:211], v[16:19], 0
    v_mfma_f32_16x16x32_bf16 v[52:55], v[212:215], v[20:23], v[52:55]
    v_mfma_f32_16x16x32_bf16 v[52:55], v[216:219], v[24:27], v[52:55]
    v_mfma_f32_16x16x32_bf16 v[52:55], v[220:223], v[28:31], v[52:55]
    v_cndmask_b32 v38, v44, v46, s[56:57]
    v_cndmask_b32 v39, v45, v47, s[56:57]
    v_max3_f32 v9, v9, v38, v39
    v_mfma_f32_16x16x32_bf16 v[56:59], v[224:227], v[16:19], 0
    v_mfma_f32_16x16x32_bf16 v[56:59], v[228:231], v[20:23], v[56:59]
    v_mfma_f32_16x16x32_bf16 v[56:59], v[232:235], v[24:27], v[56:59]
    v_mfma_f32_16x16x32_bf16 v[56:59], v[236:239], v[28:31], v[56:59]
    v_cndmask_b32 v40, v48, v50, s[56:57]
    v_cndmask_b32 v41, v49, v51, s[56:57]
    v_max3_f32 v9, v9, v40, v41
    v_mfma_f32_16x16x32_bf16 v[60:63], v[240:243], v[16:19], 0
    v_mfma_f32_16x16x32_bf16 v[60:63], v[244:247], v[20:23], v[60:63]
    v_mfma_f32_16x16x32_bf16 v[60:63], v[248:251], v[24:27], v[60:63]
    v_mfma_f32_16x16x32_bf16 v[60:63], v[252:255], v[28:31], v[60:63]
    v_cndmask_b32 v42, v52, v54, s[56:57]
    v_cndmask_b32 v43, v53, v55, s[56:57]
    v_max3_f32 v9, v9, v42, v43
    v_mov_b32 v14, 0x44444444
    v_mov_b32 v15, 0xeeeeeeee
    v_cndmask_b32 v14, v14, v15, s[56:57]
    v_cndmask_b32 v44, v56, v58, s[56:57]
    v_cndmask_b32 v45, v57, v59, s[56:57]
    v_max3_f32 v9, v9, v44, v45
    v_cndmask_b32 v46, v60, v62, s[56:57]
    v_cndmask_b32 v47, v61, v63, s[56:57]
    v_max3_f32 v9, v9, v46, v47
    s_nop 1
    v_max_f32_dpp v9, v9, v9 quad_perm:[1,0,3,2] row_mask:0xf bank_mask:0xf
    v_mov_b32 v10, v9
    s_nop 1
    v_permlane16_swap_b32 v9, v10
    v_max_f32 v9, v9, v10
    v_mov_b32 v10, v9
    s_nop 1
    v_permlane32_swap_b32 v9, v10
    v_max_f32 v9, v9, v10
    v_mul_f32 v12, s34, v9
    v_mov_b64 v[16:17], 0
    v_mov_b64 v[20:21], 0
    v_mov_b64 v[24:25], 0
    v_mov_b64 v[28:29], 0
    v_fma_f32 v32, v32, s34, -v12
    v_fma_f32 v33, v33, s34, -v12
    v_fma_f32 v34, v34, s34, -v12
    v_fma_f32 v35, v35, s34, -v12
    v_fma_f32 v36, v36, s34, -v12
    v_fma_f32 v37, v37, s34, -v12
    v_fma_f32 v38, v38, s34, -v12
    v_fma_f32 v39, v39, s34, -v12
    v_exp_f32 v32, v32
    v_exp_f32 v33, v33
    v_exp_f32 v34, v34
    v_exp_f32 v35, v35
    v_exp_f32 v36, v36
    v_exp_f32 v37, v37
    v_exp_f32 v38, v38
    v_exp_f32 v39, v39
    v_cvt_pk_bf16_f32 v48, v32, v33
    v_cvt_pk_bf16_f32 v49, v34, v35
    v_cvt_pk_bf16_f32 v50, v36, v37
    v_cvt_pk_bf16_f32 v51, v38, v39
    v_fma_f32 v40, v40, s34, -v12
    v_fma_f32 v41, v41, s34, -v12
    v_fma_f32 v42, v42, s34, -v12
    v_fma_f32 v43, v43, s34, -v12
    v_fma_f32 v44, v44, s34, -v12
    v_fma_f32 v45, v45, s34, -v12
    v_fma_f32 v46, v46, s34, -v12
    v_fma_f32 v47, v47, s34, -v12
    v_exp_f32 v40, v40
    v_exp_f32 v41, v41
    v_exp_f32 v42, v42
    v_exp_f32 v43, v43
    v_exp_f32 v44, v44
    v_exp_f32 v45, v45
    v_exp_f32 v46, v46
    v_exp_f32 v47, v47
    v_cvt_pk_bf16_f32 v52, v40, v41
    v_cvt_pk_bf16_f32 v53, v42, v43
    v_cvt_pk_bf16_f32 v54, v44, v45
    v_cvt_pk_bf16_f32 v55, v46, v47
    v_add_f32 v13, v32, v33
    v_add_f32 v15, v40, v41
    v_add_f32 v13, v13, v34
    v_add_f32 v15, v15, v42
    v_add_f32 v13, v13, v35
    v_add_f32 v15, v15, v43
    v_add_f32 v13, v13, v36
    v_add_f32 v15, v15, v44
    v_add_f32 v13, v13, v37
    v_add_f32 v15, v15, v45
    v_add_f32 v13, v13, v38
    v_add_f32 v15, v15, v46
    v_add_f32 v13, v13, v39
    v_add_f32 v15, v15, v47
    v_add_f32 v13, v13, v15
    s_nop 1
    v_add_f32_dpp v13, v13, v13 quad_perm:[1,0,3,2] row_mask:0xf bank_mask:0xf
    v_mov_b32 v10, v13
    s_nop 1
    v_permlane16_swap_b32 v13, v10
    v_add_f32 v13, v13, v10
    v_mov_b32 v10, v13
    s_nop 1
    v_permlane32_swap_b32 v13, v10
    v_add_f32 v13, v13, v10
    v_mov_b32 v11, v2
    ds_read_b64_tr_b16 v[56:57], v11 offset:0
    ds_read_b64_tr_b16 v[58:59], v11 offset:4096
    ds_read_b64_tr_b16 v[60:61], v11 offset:2048
    ds_read_b64_tr_b16 v[62:63], v11 offset:6144
    v_xor_b32 v15, 32, v2
    ds_read_b64_tr_b16 v[32:33], v15 offset:0
    ds_read_b64_tr_b16 v[34:35], v15 offset:4096
    ds_read_b64_tr_b16 v[36:37], v15 offset:2048
    ds_read_b64_tr_b16 v[38:39], v15 offset:6144
    v_xor_b32 v9, 64, v2
    ds_read_b64_tr_b16 v[40:41], v9 offset:0
    ds_read_b64_tr_b16 v[42:43], v9 offset:4096
    ds_read_b64_tr_b16 v[44:45], v9 offset:2048
    ds_read_b64_tr_b16 v[46:47], v9 offset:6144
    s_waitcnt lgkmcnt(8)
    v_smfmac_f32_16x16x64_bf16 v[64:67], v[48:51], v[56:63], v14
    v_xor_b32 v11, 96, v2
    ds_read_b64_tr_b16 v[56:57], v11 offset:0
    ds_read_b64_tr_b16 v[58:59], v11 offset:4096
    ds_read_b64_tr_b16 v[60:61], v11 offset:2048
    ds_read_b64_tr_b16 v[62:63], v11 offset:6144
    s_waitcnt lgkmcnt(8)
    v_smfmac_f32_16x16x64_bf16 v[68:71], v[48:51], v[32:39], v14
    v_xor_b32 v15, 128, v2
    ds_read_b64_tr_b16 v[32:33], v15 offset:0
    ds_read_b64_tr_b16 v[34:35], v15 offset:4096
    ds_read_b64_tr_b16 v[36:37], v15 offset:2048
    ds_read_b64_tr_b16 v[38:39], v15 offset:6144
    s_waitcnt lgkmcnt(8)
    v_smfmac_f32_16x16x64_bf16 v[72:75], v[48:51], v[40:47], v14
    v_xor_b32 v9, 160, v2
    ds_read_b64_tr_b16 v[40:41], v9 offset:0
    ds_read_b64_tr_b16 v[42:43], v9 offset:4096
    ds_read_b64_tr_b16 v[44:45], v9 offset:2048
    ds_read_b64_tr_b16 v[46:47], v9 offset:6144
    s_waitcnt lgkmcnt(8)
    v_smfmac_f32_16x16x64_bf16 v[76:79], v[48:51], v[56:63], v14
    v_xor_b32 v11, 192, v2
    ds_read_b64_tr_b16 v[56:57], v11 offset:0
    ds_read_b64_tr_b16 v[58:59], v11 offset:4096
    ds_read_b64_tr_b16 v[60:61], v11 offset:2048
    ds_read_b64_tr_b16 v[62:63], v11 offset:6144
    s_waitcnt lgkmcnt(8)
    v_smfmac_f32_16x16x64_bf16 v[16:19], v[48:51], v[32:39], v14
    v_xor_b32 v15, 224, v2
    ds_read_b64_tr_b16 v[32:33], v15 offset:0
    ds_read_b64_tr_b16 v[34:35], v15 offset:4096
    ds_read_b64_tr_b16 v[36:37], v15 offset:2048
    ds_read_b64_tr_b16 v[38:39], v15 offset:6144
    s_waitcnt lgkmcnt(8)
    v_smfmac_f32_16x16x64_bf16 v[20:23], v[48:51], v[40:47], v14
    s_waitcnt lgkmcnt(4)
    v_smfmac_f32_16x16x64_bf16 v[24:27], v[48:51], v[56:63], v14
    s_waitcnt lgkmcnt(0)
    v_smfmac_f32_16x16x64_bf16 v[28:31], v[48:51], v[32:39], v14
    v_mov_b32 v11, v2
    ds_read_b64_tr_b16 v[56:57], v11 offset:16384
    ds_read_b64_tr_b16 v[58:59], v11 offset:20480
    ds_read_b64_tr_b16 v[60:61], v11 offset:18432
    ds_read_b64_tr_b16 v[62:63], v11 offset:22528
    v_xor_b32 v15, 32, v2
    ds_read_b64_tr_b16 v[32:33], v15 offset:16384
    ds_read_b64_tr_b16 v[34:35], v15 offset:20480
    ds_read_b64_tr_b16 v[36:37], v15 offset:18432
    ds_read_b64_tr_b16 v[38:39], v15 offset:22528
    v_xor_b32 v9, 64, v2
    ds_read_b64_tr_b16 v[40:41], v9 offset:16384
    ds_read_b64_tr_b16 v[42:43], v9 offset:20480
    ds_read_b64_tr_b16 v[44:45], v9 offset:18432
    ds_read_b64_tr_b16 v[46:47], v9 offset:22528
    s_waitcnt lgkmcnt(8)
    v_smfmac_f32_16x16x64_bf16 v[64:67], v[52:55], v[56:63], v14
    v_xor_b32 v11, 96, v2
    ds_read_b64_tr_b16 v[56:57], v11 offset:16384
    ds_read_b64_tr_b16 v[58:59], v11 offset:20480
    ds_read_b64_tr_b16 v[60:61], v11 offset:18432
    ds_read_b64_tr_b16 v[62:63], v11 offset:22528
    s_waitcnt lgkmcnt(8)
    v_smfmac_f32_16x16x64_bf16 v[68:71], v[52:55], v[32:39], v14
    v_xor_b32 v15, 128, v2
    ds_read_b64_tr_b16 v[32:33], v15 offset:16384
    ds_read_b64_tr_b16 v[34:35], v15 offset:20480
    ds_read_b64_tr_b16 v[36:37], v15 offset:18432
    ds_read_b64_tr_b16 v[38:39], v15 offset:22528
    s_waitcnt lgkmcnt(8)
    v_smfmac_f32_16x16x64_bf16 v[72:75], v[52:55], v[40:47], v14
    v_xor_b32 v9, 160, v2
    ds_read_b64_tr_b16 v[40:41], v9 offset:16384
    ds_read_b64_tr_b16 v[42:43], v9 offset:20480
    ds_read_b64_tr_b16 v[44:45], v9 offset:18432
    ds_read_b64_tr_b16 v[46:47], v9 offset:22528
    s_waitcnt lgkmcnt(8)
    v_smfmac_f32_16x16x64_bf16 v[76:79], v[52:55], v[56:63], v14
    v_xor_b32 v11, 192, v2
    ds_read_b64_tr_b16 v[56:57], v11 offset:16384
    ds_read_b64_tr_b16 v[58:59], v11 offset:20480
    ds_read_b64_tr_b16 v[60:61], v11 offset:18432
    ds_read_b64_tr_b16 v[62:63], v11 offset:22528
    s_waitcnt lgkmcnt(8)
    v_smfmac_f32_16x16x64_bf16 v[16:19], v[52:55], v[32:39], v14
    v_xor_b32 v15, 224, v2
    ds_read_b64_tr_b16 v[32:33], v15 offset:16384
    ds_read_b64_tr_b16 v[34:35], v15 offset:20480
    ds_read_b64_tr_b16 v[36:37], v15 offset:18432
    ds_read_b64_tr_b16 v[38:39], v15 offset:22528
    s_waitcnt lgkmcnt(8)
    v_smfmac_f32_16x16x64_bf16 v[20:23], v[52:55], v[40:47], v14
    s_waitcnt lgkmcnt(4)
    v_smfmac_f32_16x16x64_bf16 v[24:27], v[52:55], v[56:63], v14
    s_waitcnt lgkmcnt(0)
    v_smfmac_f32_16x16x64_bf16 v[28:31], v[52:55], v[32:39], v14
    s_waitcnt vmcnt(0)
    s_branch Lwe_54
Lw1_53:
    s_add_u32 s42, s39, 6
    s_and_b32 s42, s42, 7
    s_lshl_b32 s42, s42, 12
    s_add_u32 s54, s22, s42
    s_addc_u32 s55, s23, 0
    s_lshl_b32 s41, s3, 15
    s_add_u32 s41, s41, 24576
    s_mov_b32 m0, s41
    s_nop 0
    global_load_lds_dwordx4 v8, s[54:55] offset:0 nt
    global_load_lds_dwordx4 v7, s[54:55] offset:1024 nt
    global_load_lds_dwordx4 v8, s[54:55] offset:2048 nt
    global_load_lds_dwordx4 v7, s[54:55] offset:3072 nt
    s_add_u32 s42, s39, 7
    s_and_b32 s42, s42, 7
    s_lshl_b32 s42, s42, 12
    s_add_u32 s54, s22, s42
    s_addc_u32 s55, s23, 0
    s_lshl_b32 s41, s3, 15
    s_add_u32 s41, s41, 28672
    s_mov_b32 m0, s41
    s_nop 0
    global_load_lds_dwordx4 v8, s[54:55] offset:0 nt
    global_load_lds_dwordx4 v7, s[54:55] offset:1024 nt
    global_load_lds_dwordx4 v8, s[54:55] offset:2048 nt
    global_load_lds_dwordx4 v7, s[54:55] offset:3072 nt
    v_mfma_f32_16x16x32_bf16 v[32:35], v[128:131], v[16:19], 0
    v_mfma_f32_16x16x32_bf16 v[32:35], v[132:135], v[20:23], v[32:35]
    v_mfma_f32_16x16x32_bf16 v[32:35], v[136:139], v[24:27], v[32:35]
    v_mfma_f32_16x16x32_bf16 v[32:35], v[140:143], v[28:31], v[32:35]
    v_mov_b64 v[64:65], 0
    v_mfma_f32_16x16x32_bf16 v[36:39], v[144:147], v[16:19], 0
    v_mfma_f32_16x16x32_bf16 v[36:39], v[148:151], v[20:23], v[36:39]
    v_mfma_f32_16x16x32_bf16 v[36:39], v[152:155], v[24:27], v[36:39]
    v_mfma_f32_16x16x32_bf16 v[36:39], v[156:159], v[28:31], v[36:39]
    v_mov_b64 v[68:69], 0
    v_mfma_f32_16x16x32_bf16 v[40:43], v[160:163], v[16:19], 0
    v_mfma_f32_16x16x32_bf16 v[40:43], v[164:167], v[20:23], v[40:43]
    v_mfma_f32_16x16x32_bf16 v[40:43], v[168:171], v[24:27], v[40:43]
    v_mfma_f32_16x16x32_bf16 v[40:43], v[172:175], v[28:31], v[40:43]
    v_cndmask_b32 v32, v32, v34, s[56:57]
    v_cndmask_b32 v33, v33, v35, s[56:57]
    v_max_f32 v9, v32, v33
    v_mov_b64 v[72:73], 0
    v_mfma_f32_16x16x32_bf16 v[44:47], v[176:179], v[16:19], 0
    v_mfma_f32_16x16x32_bf16 v[44:47], v[180:183], v[20:23], v[44:47]
    v_mfma_f32_16x16x32_bf16 v[44:47], v[184:187], v[24:27], v[44:47]
    v_mfma_f32_16x16x32_bf16 v[44:47], v[188:191], v[28:31], v[44:47]
    v_cndmask_b32 v34, v36, v38, s[56:57]
    v_cndmask_b32 v35, v37, v39, s[56:57]
    v_max3_f32 v9, v9, v34, v35
    v_mov_b64 v[76:77], 0
    v_mfma_f32_16x16x32_bf16 v[48:51], v[192:195], v[16:19], 0
    v_mfma_f32_16x16x32_bf16 v[48:51], v[196:199], v[20:23], v[48:51]
    v_mfma_f32_16x16x32_bf16 v[48:51], v[200:203], v[24:27], v[48:51]
    v_mfma_f32_16x16x32_bf16 v[48:51], v[204:207], v[28:31], v[48:51]
    v_cndmask_b32 v36, v40, v42, s[56:57]
    v_cndmask_b32 v37, v41, v43, s[56:57]
    v_max3_f32 v9, v9, v36, v37
    v_mfma_f32_16x16x32_bf16 v[52:55], v[208:211], v[16:19], 0
    v_mfma_f32_16x16x32_bf16 v[52:55], v[212:215], v[20:23], v[52:55]
    v_mfma_f32_16x16x32_bf16 v[52:55], v[216:219], v[24:27], v[52:55]
    v_mfma_f32_16x16x32_bf16 v[52:55], v[220:223], v[28:31], v[52:55]
    v_cndmask_b32 v38, v44, v46, s[56:57]
    v_cndmask_b32 v39, v45, v47, s[56:57]
    v_max3_f32 v9, v9, v38, v39
    v_mfma_f32_16x16x32_bf16 v[56:59], v[224:227], v[16:19], 0
    v_mfma_f32_16x16x32_bf16 v[56:59], v[228:231], v[20:23], v[56:59]
    v_mfma_f32_16x16x32_bf16 v[56:59], v[232:235], v[24:27], v[56:59]
    v_mfma_f32_16x16x32_bf16 v[56:59], v[236:239], v[28:31], v[56:59]
    v_cndmask_b32 v40, v48, v50, s[56:57]
    v_cndmask_b32 v41, v49, v51, s[56:57]
    v_max3_f32 v9, v9, v40, v41
    v_mfma_f32_16x16x32_bf16 v[60:63], v[240:243], v[16:19], 0
    v_mfma_f32_16x16x32_bf16 v[60:63], v[244:247], v[20:23], v[60:63]
    v_mfma_f32_16x16x32_bf16 v[60:63], v[248:251], v[24:27], v[60:63]
    v_mfma_f32_16x16x32_bf16 v[60:63], v[252:255], v[28:31], v[60:63]
    v_cndmask_b32 v42, v52, v54, s[56:57]
    v_cndmask_b32 v43, v53, v55, s[56:57]
    v_max3_f32 v9, v9, v42, v43
    v_mov_b32 v14, 0x44444444
    v_mov_b32 v15, 0xeeeeeeee
    v_cndmask_b32 v14, v14, v15, s[56:57]
    v_cndmask_b32 v44, v56, v58, s[56:57]
    v_cndmask_b32 v45, v57, v59, s[56:57]
    v_max3_f32 v9, v9, v44, v45
    v_cndmask_b32 v46, v60, v62, s[56:57]
    v_cndmask_b32 v47, v61, v63, s[56:57]
    v_max3_f32 v9, v9, v46, v47
    s_nop 1
    v_max_f32_dpp v9, v9, v9 quad_perm:[1,0,3,2] row_mask:0xf bank_mask:0xf
    v_mov_b32 v10, v9
    s_nop 1
    v_permlane16_swap_b32 v9, v10
    v_max_f32 v9, v9, v10
    v_mov_b32 v10, v9
    s_nop 1
    v_permlane32_swap_b32 v9, v10
    v_max_f32 v9, v9, v10
    v_mul_f32 v12, s34, v9
    v_mov_b64 v[16:17], 0
    v_mov_b64 v[20:21], 0
    v_mov_b64 v[24:25], 0
    v_mov_b64 v[28:29], 0
    v_fma_f32 v32, v32, s34, -v12
    v_fma_f32 v33, v33, s34, -v12
    v_fma_f32 v34, v34, s34, -v12
    v_fma_f32 v35, v35, s34, -v12
    v_fma_f32 v36, v36, s34, -v12
    v_fma_f32 v37, v37, s34, -v12
    v_fma_f32 v38, v38, s34, -v12
    v_fma_f32 v39, v39, s34, -v12
    v_exp_f32 v32, v32
    v_exp_f32 v33, v33
    v_exp_f32 v34, v34
    v_exp_f32 v35, v35
    v_exp_f32 v36, v36
    v_exp_f32 v37, v37
    v_exp_f32 v38, v38
    v_exp_f32 v39, v39
    v_cvt_pk_bf16_f32 v48, v32, v33
    v_cvt_pk_bf16_f32 v49, v34, v35
    v_cvt_pk_bf16_f32 v50, v36, v37
    v_cvt_pk_bf16_f32 v51, v38, v39
    v_fma_f32 v40, v40, s34, -v12
    v_fma_f32 v41, v41, s34, -v12
    v_fma_f32 v42, v42, s34, -v12
    v_fma_f32 v43, v43, s34, -v12
    v_fma_f32 v44, v44, s34, -v12
    v_fma_f32 v45, v45, s34, -v12
    v_fma_f32 v46, v46, s34, -v12
    v_fma_f32 v47, v47, s34, -v12
    v_exp_f32 v40, v40
    v_exp_f32 v41, v41
    v_exp_f32 v42, v42
    v_exp_f32 v43, v43
    v_exp_f32 v44, v44
    v_exp_f32 v45, v45
    v_exp_f32 v46, v46
    v_exp_f32 v47, v47
    v_cvt_pk_bf16_f32 v52, v40, v41
    v_cvt_pk_bf16_f32 v53, v42, v43
    v_cvt_pk_bf16_f32 v54, v44, v45
    v_cvt_pk_bf16_f32 v55, v46, v47
    v_add_f32 v13, v32, v33
    v_add_f32 v15, v40, v41
    v_add_f32 v13, v13, v34
    v_add_f32 v15, v15, v42
    v_add_f32 v13, v13, v35
    v_add_f32 v15, v15, v43
    v_add_f32 v13, v13, v36
    v_add_f32 v15, v15, v44
    v_add_f32 v13, v13, v37
    v_add_f32 v15, v15, v45
    v_add_f32 v13, v13, v38
    v_add_f32 v15, v15, v46
    v_add_f32 v13, v13, v39
    v_add_f32 v15, v15, v47
    v_add_f32 v13, v13, v15
    s_nop 1
    v_add_f32_dpp v13, v13, v13 quad_perm:[1,0,3,2] row_mask:0xf bank_mask:0xf
    v_mov_b32 v10, v13
    s_nop 1
    v_permlane16_swap_b32 v13, v10
    v_add_f32 v13, v13, v10
    v_mov_b32 v10, v13
    s_nop 1
    v_permlane32_swap_b32 v13, v10
    v_add_f32 v13, v13, v10
    v_lshrrev_b32 v9, 3, v0
    v_mul_u32_u24 v9, 1024, v9
    v_and_b32 v10, 7, v0
    v_lshl_add_u32 v9, v10, 4, v9
    s_lshl_b32 s41, s3, 12
    s_add_u32 s41, s41, 131072
    s_mov_b32 m0, s41
    s_nop 0
    global_load_lds_dwordx4 v9, s[30:31] nt
    s_add_u32 s30, s30, 8192
    s_addc_u32 s31, s31, 0
    s_add_u32 s41, s41, 1024
    s_mov_b32 m0, s41
    s_nop 0
    global_load_lds_dwordx4 v9, s[30:31] nt
    s_add_u32 s30, s30, 8192
    s_addc_u32 s31, s31, 0
    s_add_u32 s41, s41, 1024
    s_mov_b32 m0, s41
    s_nop 0
    global_load_lds_dwordx4 v9, s[30:31] nt
    s_add_u32 s30, s30, 8192
    s_addc_u32 s31, s31, 0
    s_add_u32 s41, s41, 1024
    s_mov_b32 m0, s41
    s_nop 0
    global_load_lds_dwordx4 v9, s[30:31] nt
    s_waitcnt vmcnt(20)
    v_mov_b32 v11, v2
    ds_read_b64_tr_b16 v[56:57], v11 offset:0
    ds_read_b64_tr_b16 v[58:59], v11 offset:4096
    ds_read_b64_tr_b16 v[60:61], v11 offset:2048
    ds_read_b64_tr_b16 v[62:63], v11 offset:6144
    v_xor_b32 v15, 32, v2
    ds_read_b64_tr_b16 v[32:33], v15 offset:0
    ds_read_b64_tr_b16 v[34:35], v15 offset:4096
    ds_read_b64_tr_b16 v[36:37], v15 offset:2048
    ds_read_b64_tr_b16 v[38:39], v15 offset:6144
    v_xor_b32 v9, 64, v2
    ds_read_b64_tr_b16 v[40:41], v9 offset:0
    ds_read_b64_tr_b16 v[42:43], v9 offset:4096
    ds_read_b64_tr_b16 v[44:45], v9 offset:2048
    ds_read_b64_tr_b16 v[46:47], v9 offset:6144
    s_waitcnt lgkmcnt(8)
    v_smfmac_f32_16x16x64_bf16 v[64:67], v[48:51], v[56:63], v14
    v_xor_b32 v11, 96, v2
    ds_read_b64_tr_b16 v[56:57], v11 offset:0
    ds_read_b64_tr_b16 v[58:59], v11 offset:4096
    ds_read_b64_tr_b16 v[60:61], v11 offset:2048
    ds_read_b64_tr_b16 v[62:63], v11 offset:6144
    s_waitcnt lgkmcnt(8)
    v_smfmac_f32_16x16x64_bf16 v[68:71], v[48:51], v[32:39], v14
    v_xor_b32 v15, 128, v2
    ds_read_b64_tr_b16 v[32:33], v15 offset:0
    ds_read_b64_tr_b16 v[34:35], v15 offset:4096
    ds_read_b64_tr_b16 v[36:37], v15 offset:2048
    ds_read_b64_tr_b16 v[38:39], v15 offset:6144
    s_waitcnt lgkmcnt(8)
    v_smfmac_f32_16x16x64_bf16 v[72:75], v[48:51], v[40:47], v14
    v_xor_b32 v9, 160, v2
    ds_read_b64_tr_b16 v[40:41], v9 offset:0
    ds_read_b64_tr_b16 v[42:43], v9 offset:4096
    ds_read_b64_tr_b16 v[44:45], v9 offset:2048
    ds_read_b64_tr_b16 v[46:47], v9 offset:6144
    s_waitcnt lgkmcnt(8)
    v_smfmac_f32_16x16x64_bf16 v[76:79], v[48:51], v[56:63], v14
    v_xor_b32 v11, 192, v2
    ds_read_b64_tr_b16 v[56:57], v11 offset:0
    ds_read_b64_tr_b16 v[58:59], v11 offset:4096
    ds_read_b64_tr_b16 v[60:61], v11 offset:2048
    ds_read_b64_tr_b16 v[62:63], v11 offset:6144
    s_waitcnt lgkmcnt(8)
    v_smfmac_f32_16x16x64_bf16 v[16:19], v[48:51], v[32:39], v14
    v_xor_b32 v15, 224, v2
    ds_read_b64_tr_b16 v[32:33], v15 offset:0
    ds_read_b64_tr_b16 v[34:35], v15 offset:4096
    ds_read_b64_tr_b16 v[36:37], v15 offset:2048
    ds_read_b64_tr_b16 v[38:39], v15 offset:6144
    s_waitcnt lgkmcnt(8)
    v_smfmac_f32_16x16x64_bf16 v[20:23], v[48:51], v[40:47], v14
    s_waitcnt lgkmcnt(4)
    v_smfmac_f32_16x16x64_bf16 v[24:27], v[48:51], v[56:63], v14
    s_waitcnt lgkmcnt(0)
    v_smfmac_f32_16x16x64_bf16 v[28:31], v[48:51], v[32:39], v14
    s_waitcnt vmcnt(4)
    v_mov_b32 v11, v2
    ds_read_b64_tr_b16 v[56:57], v11 offset:16384
    ds_read_b64_tr_b16 v[58:59], v11 offset:20480
    ds_read_b64_tr_b16 v[60:61], v11 offset:18432
    ds_read_b64_tr_b16 v[62:63], v11 offset:22528
    v_xor_b32 v15, 32, v2
    ds_read_b64_tr_b16 v[32:33], v15 offset:16384
    ds_read_b64_tr_b16 v[34:35], v15 offset:20480
    ds_read_b64_tr_b16 v[36:37], v15 offset:18432
    ds_read_b64_tr_b16 v[38:39], v15 offset:22528
    v_xor_b32 v9, 64, v2
    ds_read_b64_tr_b16 v[40:41], v9 offset:16384
    ds_read_b64_tr_b16 v[42:43], v9 offset:20480
    ds_read_b64_tr_b16 v[44:45], v9 offset:18432
    ds_read_b64_tr_b16 v[46:47], v9 offset:22528
    s_waitcnt lgkmcnt(8)
    v_smfmac_f32_16x16x64_bf16 v[64:67], v[52:55], v[56:63], v14
    v_xor_b32 v11, 96, v2
    ds_read_b64_tr_b16 v[56:57], v11 offset:16384
    ds_read_b64_tr_b16 v[58:59], v11 offset:20480
    ds_read_b64_tr_b16 v[60:61], v11 offset:18432
    ds_read_b64_tr_b16 v[62:63], v11 offset:22528
    s_waitcnt lgkmcnt(8)
    v_smfmac_f32_16x16x64_bf16 v[68:71], v[52:55], v[32:39], v14
    v_xor_b32 v15, 128, v2
    ds_read_b64_tr_b16 v[32:33], v15 offset:16384
    ds_read_b64_tr_b16 v[34:35], v15 offset:20480
    ds_read_b64_tr_b16 v[36:37], v15 offset:18432
    ds_read_b64_tr_b16 v[38:39], v15 offset:22528
    s_waitcnt lgkmcnt(8)
    v_smfmac_f32_16x16x64_bf16 v[72:75], v[52:55], v[40:47], v14
    v_xor_b32 v9, 160, v2
    ds_read_b64_tr_b16 v[40:41], v9 offset:16384
    ds_read_b64_tr_b16 v[42:43], v9 offset:20480
    ds_read_b64_tr_b16 v[44:45], v9 offset:18432
    ds_read_b64_tr_b16 v[46:47], v9 offset:22528
    s_waitcnt lgkmcnt(8)
    v_smfmac_f32_16x16x64_bf16 v[76:79], v[52:55], v[56:63], v14
    v_xor_b32 v11, 192, v2
    ds_read_b64_tr_b16 v[56:57], v11 offset:16384
    ds_read_b64_tr_b16 v[58:59], v11 offset:20480
    ds_read_b64_tr_b16 v[60:61], v11 offset:18432
    ds_read_b64_tr_b16 v[62:63], v11 offset:22528
    s_waitcnt lgkmcnt(8)
    v_smfmac_f32_16x16x64_bf16 v[16:19], v[52:55], v[32:39], v14
    v_xor_b32 v15, 224, v2
    ds_read_b64_tr_b16 v[32:33], v15 offset:16384
    ds_read_b64_tr_b16 v[34:35], v15 offset:20480
    ds_read_b64_tr_b16 v[36:37], v15 offset:18432
    ds_read_b64_tr_b16 v[38:39], v15 offset:22528
    s_waitcnt lgkmcnt(8)
    v_smfmac_f32_16x16x64_bf16 v[20:23], v[52:55], v[40:47], v14
    s_waitcnt lgkmcnt(4)
    v_smfmac_f32_16x16x64_bf16 v[24:27], v[52:55], v[56:63], v14
    s_waitcnt lgkmcnt(0)
    v_smfmac_f32_16x16x64_bf16 v[28:31], v[52:55], v[32:39], v14
    s_waitcnt vmcnt(0)
Lwe_54:
    v_and_b32 v9, 15, v0
    v_lshlrev_b32 v9, 2, v9
    s_lshl_b32 s41, s3, 9
    s_add_u32 s41, s41, 147456
    v_add_u32 v9, s41, v9
    s_lshl_b32 s41, s3, 3
    s_add_u32 s41, s41, 149504
    v_mov_b32 v10, s41
    s_mov_b32 exec_lo, 0xffff
    s_mov_b32 exec_hi, 0
    v_add_f32 v64, v64, v65
    v_add_f32 v68, v68, v69
    ds_write2_b32 v9, v64, v68 offset0:0 offset1:16
    v_add_f32 v72, v72, v73
    v_add_f32 v76, v76, v77
    ds_write2_b32 v9, v72, v76 offset0:32 offset1:48
    v_add_f32 v16, v16, v17
    v_add_f32 v20, v20, v21
    ds_write2_b32 v9, v16, v20 offset0:64 offset1:80
    v_add_f32 v24, v24, v25
    v_add_f32 v28, v28, v29
    ds_write2_b32 v9, v24, v28 offset0:96 offset1:112
    s_mov_b64 exec, 1
    ds_write_b64 v10, v[12:13]
    s_mov_b64 exec, -1
    s_waitcnt lgkmcnt(0)
    s_barrier
    s_cmp_lg_u32 s3, 0
    s_cbranch_scc1 Lw1_55
    v_lshlrev_b32 v9, 3, v0
    v_add_u32 v10, 147456, v9
    v_mov_b32 v11, 149504
    ds_read_b128 v[48:51], v11
    ds_read_b128 v[52:55], v11 offset:16
    ds_read_b64 v[32:33], v10 offset:0
    ds_read_b64 v[34:35], v10 offset:512
    ds_read_b64 v[36:37], v10 offset:1024
    ds_read_b64 v[38:39], v10 offset:1536
    s_lshl_b32 s41, s4, 15
    s_lshl_b32 s42, s5, 10
    s_add_u32 s41, s41, s42
    s_add_u32 s41, s41, 2359296
    v_add_u32 v9, s41, v9
    v_mov_b32 v10, s41
    s_waitcnt lgkmcnt(4)
    v_max3_f32 v56, v48, v50, v52
    v_mov_b32 v58, v1
    v_max_f32 v56, v56, v54
    v_mov_b32 v59, v1
    v_sub_f32 v48, v48, v56
    v_sub_f32 v50, v50, v56
    v_sub_f32 v52, v52, v56
    v_sub_f32 v54, v54, v56
    v_exp_f32 v48, v48
    v_exp_f32 v50, v50
    v_exp_f32 v52, v52
    v_exp_f32 v54, v54
    s_waitcnt lgkmcnt(0)
    v_mul_f32 v32, v48, v32
    v_mul_f32 v33, v48, v33
    v_mul_f32 v57, v48, v49
    v_fmac_f32 v32, v50, v34
    v_fmac_f32 v33, v50, v35
    v_fmac_f32 v57, v50, v51
    v_fmac_f32 v32, v52, v36
    v_fmac_f32 v33, v52, v37
    v_fmac_f32 v57, v52, v53
    v_fmac_f32 v32, v54, v38
    v_fmac_f32 v33, v54, v39
    v_fmac_f32 v57, v54, v55
    v_bfi_b32 v32, s35, v32, v1
    v_bfi_b32 v33, s35, v33, v1
    s_cmp_eq_u32 s13, 0
    s_cbranch_scc1 Lpg_57
    global_store_dwordx2 v9, v[32:33], s[10:11]
    s_mov_b64 exec, 1
    global_store_dwordx4 v10, v[56:59], s[10:11] offset:512
    s_mov_b64 exec, -1
    s_branch Lpe_58
Lpg_57:
    global_store_dwordx2 v9, v[32:33], s[10:11] sc1
    s_mov_b64 exec, 1
    global_store_dwordx4 v10, v[56:59], s[10:11] offset:512 sc1
    s_mov_b64 exec, -1
Lpe_58:
    s_lshr_b32 s41, s5, 2
    s_lshl_b32 s41, s41, 2
    s_add_u32 s41, s41, s3
    s_lshl_b32 s41, s41, 12
    s_lshl_b32 s42, s4, 2
    s_add_u32 s42, s42, s9
    s_lshl_b32 s42, s42, 7
    s_add_u32 s41, s41, s42
    s_add_u32 s41, s41, 655360
    v_and_b32 v14, 31, v0
    v_lshlrev_b32 v14, 2, v14
    v_add_u32 v14, s41, v14
    v_lshrrev_b32 v12, 4, v0
    v_lshlrev_b32 v12, 3, v12
    v_bfe_u32 v15, v0, 2, 2
    v_add_u32 v12, v12, v15
    v_lshlrev_b32 v12, 7, v12
    v_and_b32 v15, 3, v0
    v_lshl_add_u32 v12, v15, 3, v12
    s_lshl_b32 s41, s3, 5
    s_add_u32 s41, s41, 131072
    v_add_u32 v12, s41, v12
    ds_read_b64_tr_b16 v[64:65], v12 offset:0
    ds_read_b64_tr_b16 v[66:67], v12 offset:512
    ds_read_b64_tr_b16 v[68:69], v12 offset:4096
    ds_read_b64_tr_b16 v[70:71], v12 offset:4608
    ds_read_b64_tr_b16 v[72:73], v12 offset:8192
    ds_read_b64_tr_b16 v[74:75], v12 offset:8704
    ds_read_b64_tr_b16 v[76:77], v12 offset:12288
    ds_read_b64_tr_b16 v[78:79], v12 offset:12800
    v_lshrrev_b32 v9, 5, v0
    v_lshlrev_b32 v9, 12, v9
    s_lshl_b32 s41, s4, 15
    s_lshl_b32 s42, s9, 13
    s_add_u32 s41, s41, s42
    s_add_u32 s41, s41, 2359296
    v_add_u32 v9, s41, v9
    v_and_b32 v10, 3, v0
    v_lshl_add_u32 v10, v10, 10, v9
    v_and_b32 v11, 31, v0
    v_lshl_add_u32 v9, v11, 4, v9
    v_lshlrev_b32 v11, 3, v11
    v_lshrrev_b32 v15, 5, v0
    v_mul_u32_u24 v15, 320, v15
    v_add_u32 v11, v11, v15
    v_add_u32 v11, 150528, v11
    s_mov_b32 s38, 0
Lpoll_59:
    global_load_dwordx4 v[32:35], v9, s[10:11] offset:0 sc1
    global_load_dwordx4 v[36:39], v9, s[10:11] offset:1024 sc1
    global_load_dwordx4 v[40:43], v9, s[10:11] offset:2048 sc1
    global_load_dwordx4 v[44:47], v9, s[10:11] offset:3072 sc1
    global_load_dwordx4 v[48:51], v10, s[10:11] offset:512 sc1
    s_waitcnt vmcnt(0)
    v_xor_b32 v32, s50, v32
    v_xor_b32 v33, s50, v33
    v_xor_b32 v34, s50, v34
    v_xor_b32 v35, s50, v35
    v_xor_b32 v36, s50, v36
    v_xor_b32 v37, s50, v37
    v_xor_b32 v38, s50, v38
    v_xor_b32 v39, s50, v39
    v_xor_b32 v40, s50, v40
    v_xor_b32 v41, s50, v41
    v_xor_b32 v42, s50, v42
    v_xor_b32 v43, s50, v43
    v_xor_b32 v44, s50, v44
    v_xor_b32 v45, s50, v45
    v_xor_b32 v46, s50, v46
    v_xor_b32 v47, s50, v47
    v_or3_b32 v15, v32, v33, v34
    v_or3_b32 v15, v15, v35, v36
    v_or3_b32 v15, v15, v37, v38
    v_or3_b32 v15, v15, v39, v40
    v_or3_b32 v15, v15, v41, v42
    v_or3_b32 v15, v15, v43, v44
    v_or3_b32 v15, v15, v45, v46
    v_or_b32 v15, v15, v47
    v_and_b32 v15, 0xff, v15
    v_bitop3_b32 v15, v50, v15, v1 bitop3:0xDE
    v_bitop3_b32 v15, v51, v15, v1 bitop3:0xDE
    v_cmp_eq_u32 vcc, 0, v15
    s_nop 0
    s_cmp_eq_u64 vcc, exec
    s_cbranch_scc1 Lpdone_60
Lpretry_61:
    s_add_u32 s38, s38, 1
    s_cmp_lt_u32 s38, 65536
    s_cbranch_scc1 Lpoll_59
Lpdone_60:
    v_max_f32_dpp v9, v48, v48 quad_perm:[1,0,3,2] row_mask:0xf bank_mask:0xf
    s_nop 1
    v_max_f32_dpp v9, v9, v9 quad_perm:[2,3,0,1] row_mask:0xf bank_mask:0xf
    v_sub_f32 v48, v48, v9
    v_exp_f32 v48, v48
    s_nop 0
    v_mul_f32 v49, v48, v49
    s_nop 1
    v_add_f32_dpp v9, v49, v49 quad_perm:[1,0,3,2] row_mask:0xf bank_mask:0xf
    s_nop 1
    v_add_f32_dpp v9, v9, v9 quad_perm:[2,3,0,1] row_mask:0xf bank_mask:0xf
    v_rcp_f32 v9, v9
    s_nop 0
    v_mul_f32 v48, v48, v9
    s_nop 1
    v_mul_f32_dpp v52, v48, v32 quad_perm:[0,0,0,0] row_mask:0xf bank_mask:0xf
    v_mul_f32_dpp v53, v48, v33 quad_perm:[0,0,0,0] row_mask:0xf bank_mask:0xf
    v_mul_f32_dpp v54, v48, v34 quad_perm:[0,0,0,0] row_mask:0xf bank_mask:0xf
    v_mul_f32_dpp v55, v48, v35 quad_perm:[0,0,0,0] row_mask:0xf bank_mask:0xf
    v_fmac_f32_dpp v52, v48, v36 quad_perm:[1,1,1,1] row_mask:0xf bank_mask:0xf
    v_fmac_f32_dpp v53, v48, v37 quad_perm:[1,1,1,1] row_mask:0xf bank_mask:0xf
    v_fmac_f32_dpp v54, v48, v38 quad_perm:[1,1,1,1] row_mask:0xf bank_mask:0xf
    v_fmac_f32_dpp v55, v48, v39 quad_perm:[1,1,1,1] row_mask:0xf bank_mask:0xf
    v_fmac_f32_dpp v52, v48, v40 quad_perm:[2,2,2,2] row_mask:0xf bank_mask:0xf
    v_fmac_f32_dpp v53, v48, v41 quad_perm:[2,2,2,2] row_mask:0xf bank_mask:0xf
    v_fmac_f32_dpp v54, v48, v42 quad_perm:[2,2,2,2] row_mask:0xf bank_mask:0xf
    v_fmac_f32_dpp v55, v48, v43 quad_perm:[2,2,2,2] row_mask:0xf bank_mask:0xf
    v_fmac_f32_dpp v52, v48, v44 quad_perm:[3,3,3,3] row_mask:0xf bank_mask:0xf
    v_fmac_f32_dpp v53, v48, v45 quad_perm:[3,3,3,3] row_mask:0xf bank_mask:0xf
    v_fmac_f32_dpp v54, v48, v46 quad_perm:[3,3,3,3] row_mask:0xf bank_mask:0xf
    v_fmac_f32_dpp v55, v48, v47 quad_perm:[3,3,3,3] row_mask:0xf bank_mask:0xf
    v_cvt_pk_bf16_f32 v52, v52, v53
    v_cvt_pk_bf16_f32 v53, v54, v55
    ds_write_b64 v11, v[52:53]
    s_branch Lwe_56
Lw1_55:
    s_lshr_b32 s41, s5, 2
    s_lshl_b32 s41, s41, 2
    s_add_u32 s41, s41, s3
    s_lshl_b32 s41, s41, 12
    s_lshl_b32 s42, s4, 2
    s_add_u32 s42, s42, s9
    s_lshl_b32 s42, s42, 7
    s_add_u32 s41, s41, s42
    s_add_u32 s41, s41, 655360
    v_and_b32 v14, 31, v0
    v_lshlrev_b32 v14, 2, v14
    v_add_u32 v14, s41, v14
    v_lshrrev_b32 v12, 4, v0
    v_lshlrev_b32 v12, 3, v12
    v_bfe_u32 v15, v0, 2, 2
    v_add_u32 v12, v12, v15
    v_lshlrev_b32 v12, 7, v12
    v_and_b32 v15, 3, v0
    v_lshl_add_u32 v12, v15, 3, v12
    s_lshl_b32 s41, s3, 5
    s_add_u32 s41, s41, 131072
    v_add_u32 v12, s41, v12
    ds_read_b64_tr_b16 v[64:65], v12 offset:0
    ds_read_b64_tr_b16 v[66:67], v12 offset:512
    ds_read_b64_tr_b16 v[68:69], v12 offset:4096
    ds_read_b64_tr_b16 v[70:71], v12 offset:4608
    ds_read_b64_tr_b16 v[72:73], v12 offset:8192
    ds_read_b64_tr_b16 v[74:75], v12 offset:8704
    ds_read_b64_tr_b16 v[76:77], v12 offset:12288
    ds_read_b64_tr_b16 v[78:79], v12 offset:12800
    v_not_b32 v15, v1
    s_lshr_b32 s41, s5, 2
    s_lshl_b32 s41, s41, 2
    s_add_u32 s41, s41, s3
    s_lshl_b32 s41, s41, 12
    s_lshl_b32 s42, s4, 2
    s_add_u32 s42, s42, s9
    s_lshl_b32 s42, s42, 7
    s_add_u32 s41, s41, s42
    s_add_u32 s41, s41, 786432
    v_and_b32 v14, 31, v0
    v_lshlrev_b32 v14, 2, v14
    v_add_u32 v14, s41, v14
    s_mov_b32 exec_lo, 0xffffffff
    s_mov_b32 exec_hi, 0
    global_store_dword v14, v15, s[10:11] sc1
    s_mov_b64 exec, -1
    s_lshr_b32 s41, s5, 2
    s_lshl_b32 s41, s41, 2
    s_add_u32 s41, s41, s3
    s_lshl_b32 s41, s41, 12
    s_lshl_b32 s42, s4, 2
    s_add_u32 s42, s42, s9
    s_lshl_b32 s42, s42, 7
    s_add_u32 s41, s41, s42
    s_add_u32 s41, s41, 917504
    v_and_b32 v14, 31, v0
    v_lshlrev_b32 v14, 2, v14
    v_add_u32 v14, s41, v14
    s_mov_b32 exec_lo, 0xffffffff
    s_mov_b32 exec_hi, 0
    global_store_dword v14, v15, s[10:11] sc1
    s_mov_b64 exec, -1
    s_lshr_b32 s41, s5, 2
    s_lshl_b32 s41, s41, 2
    s_add_u32 s41, s41, s3
    s_lshl_b32 s41, s41, 12
    s_lshl_b32 s42, s4, 2
    s_add_u32 s42, s42, s9
    s_lshl_b32 s42, s42, 7
    s_add_u32 s41, s41, s42
    s_add_u32 s41, s41, 655360
    v_and_b32 v14, 31, v0
    v_lshlrev_b32 v14, 2, v14
    v_add_u32 v14, s41, v14
Lwe_56:
    s_waitcnt lgkmcnt(0)
    s_barrier
    ds_read_b128 v[16:19], v4 offset:0
    ds_read_b128 v[20:23], v4 offset:64
    ds_read_b128 v[24:27], v4 offset:128
    ds_read_b128 v[28:31], v4 offset:192
    s_waitcnt lgkmcnt(3)
    v_mfma_f32_16x16x32_bf16 v[56:59], v[16:19], v[64:67], 0
    s_waitcnt lgkmcnt(2)
    v_mfma_f32_16x16x32_bf16 v[56:59], v[20:23], v[68:71], v[56:59]
    s_waitcnt lgkmcnt(1)
    v_mfma_f32_16x16x32_bf16 v[56:59], v[24:27], v[72:75], v[56:59]
    s_waitcnt lgkmcnt(0)
    v_mfma_f32_16x16x32_bf16 v[56:59], v[28:31], v[76:79], v[56:59]
    s_nop 7
    v_cndmask_b32 v32, v57, v56, s[46:47]
    v_bfi_b32 v32, s35, v32, v1
    s_mov_b32 exec_lo, 0xffffffff
    s_mov_b32 exec_hi, 0
    global_store_dword v14, v32, s[10:11] sc1
    s_mov_b64 exec, -1
    s_cmp_lg_u32 s3, 0
    s_cbranch_scc1 Lw1_62
    v_not_b32 v15, v1
    s_lshr_b32 s41, s5, 2
    s_lshl_b32 s41, s41, 2
    s_add_u32 s41, s41, s3
    s_lshl_b32 s41, s41, 12
    s_lshl_b32 s42, s4, 2
    s_add_u32 s42, s42, s9
    s_lshl_b32 s42, s42, 7
    s_add_u32 s41, s41, s42
    s_add_u32 s41, s41, 786432
    v_and_b32 v14, 31, v0
    v_lshlrev_b32 v14, 2, v14
    v_add_u32 v14, s41, v14
    s_mov_b32 exec_lo, 0xffffffff
    s_mov_b32 exec_hi, 0
    global_store_dword v14, v15, s[10:11] sc1
    s_mov_b64 exec, -1
    s_lshr_b32 s41, s5, 2
    s_lshl_b32 s41, s41, 2
    s_add_u32 s41, s41, s3
    s_lshl_b32 s41, s41, 12
    s_lshl_b32 s42, s4, 2
    s_add_u32 s42, s42, s9
    s_lshl_b32 s42, s42, 7
    s_add_u32 s41, s41, s42
    s_add_u32 s41, s41, 917504
    v_and_b32 v14, 31, v0
    v_lshlrev_b32 v14, 2, v14
    v_add_u32 v14, s41, v14
    s_mov_b32 exec_lo, 0xffffffff
    s_mov_b32 exec_hi, 0
    global_store_dword v14, v15, s[10:11] sc1
    s_mov_b64 exec, -1
    s_lshl_b32 s41, s5, 12
    s_add_u32 s41, s41, 655360
    v_lshlrev_b32 v13, 4, v0
    v_add_u32 v13, s41, v13
    v_and_b32 v9, 7, v0
    v_lshrrev_b32 v10, 4, v0
    v_lshl_add_u32 v9, v9, 2, v10
    v_lshlrev_b32 v9, 2, v9
    s_lshl_b32 s41, s4, 12
    s_lshl_b32 s42, s5, 7
    s_add_u32 s41, s41, s42
    s_add_u32 s41, s41, 131072
    v_add_u32 v9, s41, v9
    s_lshl_b32 s41, s4, 9
    s_lshl_b32 s42, s5, 4
    s_add_u32 s41, s41, s42
    s_add_u32 s41, s41, 270336
    v_bfe_u32 v10, v0, 2, 1
    v_lshlrev_b32 v10, 3, v10
    v_add_u32 v10, s41, v10
    s_lshl_b32 s41, s4, 12
    s_lshl_b32 s42, s45, 10
    s_add_u32 s41, s41, s42
    s_add_u32 s41, s41, 131072
    v_lshlrev_b32 v12, 4, v0
    v_add_u32 v12, s41, v12
    v_bfe_u32 v11, v0, 2, 1
    v_mul_u32_u24 v11, 320, v11
    v_lshrrev_b32 v15, 3, v0
    v_lshl_add_u32 v11, v15, 5, v11
    v_and_b32 v15, 3, v0
    v_lshl_add_u32 v11, v15, 3, v11
    v_add_u32 v11, 152064, v11
    s_mov_b32 s38, 0
    s_sleep 11
Lpoll_64:
    global_load_dwordx4 v[32:35], v13, s[10:11] offset:0 sc1
    global_load_dwordx4 v[36:39], v13, s[10:11] offset:1024 sc1
    global_load_dwordx4 v[40:43], v13, s[10:11] offset:2048 sc1
    global_load_dwordx4 v[44:47], v13, s[10:11] offset:3072 sc1
    s_waitcnt vmcnt(0)
    v_xor_b32 v32, s50, v32
    v_xor_b32 v33, s50, v33
    v_xor_b32 v34, s50, v34
    v_xor_b32 v35, s50, v35
    v_xor_b32 v36, s50, v36
    v_xor_b32 v37, s50, v37
    v_xor_b32 v38, s50, v38
    v_xor_b32 v39, s50, v39
    v_xor_b32 v40, s50, v40
    v_xor_b32 v41, s50, v41
    v_xor_b32 v42, s50, v42
    v_xor_b32 v43, s50, v43
    v_xor_b32 v44, s50, v44
    v_xor_b32 v45, s50, v45
    v_xor_b32 v46, s50, v46
    v_xor_b32 v47, s50, v47
    v_or3_b32 v15, v32, v33, v34
    v_or3_b32 v15, v15, v35, v36
    v_or3_b32 v15, v15, v37, v38
    v_or3_b32 v15, v15, v39, v40
    v_or3_b32 v15, v15, v41, v42
    v_or3_b32 v15, v15, v43, v44
    v_or3_b32 v15, v15, v45, v46
    v_or_b32 v15, v15, v47
    v_and_b32 v15, 0xff, v15
    v_cmp_eq_u32 vcc, 0, v15
    s_nop 0
    s_cmp_eq_u64 vcc, exec
    s_cbranch_scc1 Lpdone_65
Lpretry_66:
    s_add_u32 s38, s38, 1
    s_cmp_lt_u32 s38, 65536
    s_cbranch_scc1 Lpoll_64
Lpdone_65:
    v_add_f32 v32, v32, v36
    v_add_f32 v40, v40, v44
    v_add_f32 v33, v33, v37
    v_add_f32 v41, v41, v45
    v_add_f32 v34, v34, v38
    v_add_f32 v42, v42, v46
    v_add_f32 v35, v35, v39
    v_add_f32 v43, v43, v47
    v_add_f32 v32, v32, v40
    v_add_f32 v33, v33, v41
    v_add_f32 v34, v34, v42
    v_add_f32 v35, v35, v43
    v_add_f32_dpp v32, v32, v32 row_ror:8 row_mask:0xf bank_mask:0xf
    v_add_f32_dpp v33, v33, v33 row_ror:8 row_mask:0xf bank_mask:0xf
    v_add_f32_dpp v34, v34, v34 row_ror:8 row_mask:0xf bank_mask:0xf
    v_add_f32_dpp v35, v35, v35 row_ror:8 row_mask:0xf bank_mask:0xf
    v_permlane16_swap_b32 v32, v33
    s_nop 0
    v_permlane16_swap_b32 v34, v35
    v_add_f32 v32, v32, v33
    v_add_f32 v34, v34, v35
    s_nop 1
    v_permlane32_swap_b32 v32, v34
    v_add_f32 v32, v32, v34
    v_cvt_pk_bf16_f32 v32, v32, v32
    v_and_b32 v32, 0xffff0000, v32
    v_add_f32 v32, v3, v32
    v_cvt_pk_bf16_f32 v32, v32, v32
    v_and_b32 v3, 0xffff0000, v32
    v_bfi_b32 v32, s36, v3, v1
    s_mov_b32 exec_lo, 0xff00ff
    s_mov_b32 exec_hi, 0xff00ff
    s_cmp_eq_u32 s13, 0
    s_cbranch_scc1 Lpg_67
    global_store_dword v9, v32, s[10:11]
    s_branch Lpe_68
Lpg_67:
    global_store_dword v9, v32, s[10:11] sc1
Lpe_68:
    s_mov_b64 exec, -1
    v_mul_f32 v37, v3, v3
    v_add_f32_dpp v36, v3, v3 quad_perm:[1,0,3,2] row_mask:0xf bank_mask:0xf
    s_nop 0
    v_add_f32_dpp v37, v37, v37 quad_perm:[1,0,3,2] row_mask:0xf bank_mask:0xf
    v_add_f32_dpp v36, v36, v36 quad_perm:[2,3,0,1] row_mask:0xf bank_mask:0xf
    s_nop 0
    v_add_f32_dpp v37, v37, v37 quad_perm:[2,3,0,1] row_mask:0xf bank_mask:0xf
    v_mov_b32 v38, v36
    v_mov_b32 v39, v37
    s_nop 0
    v_permlane16_swap_b32 v36, v38
    v_permlane16_swap_b32 v37, v39
    v_add_f32 v36, v36, v38
    v_add_f32 v37, v37, v39
    v_mov_b32 v38, v36
    v_mov_b32 v39, v37
    s_nop 0
    v_permlane32_swap_b32 v36, v38
    v_permlane32_swap_b32 v37, v39
    v_add_f32 v36, v36, v38
    v_add_f32 v37, v37, v39
    v_bfi_b32 v36, s35, v36, v1
    v_bfi_b32 v37, s35, v37, v1
    s_mov_b64 exec, 17
    s_cmp_eq_u32 s13, 0
    s_cbranch_scc1 Lpg_69
    global_store_dwordx2 v10, v[36:37], s[10:11]
    s_branch Lpe_70
Lpg_69:
    global_store_dwordx2 v10, v[36:37], s[10:11] sc1
Lpe_70:
    s_mov_b64 exec, -1
    s_lshl_b32 s41, s4, 14
    s_lshl_b32 s44, s6, 12
    s_add_u32 s41, s41, s44
    s_add_u32 s41, s41, 1310720
    s_lshl_b32 s42, s45, 10
    s_add_u32 s41, s41, s42
    s_and_b32 s42, s5, 1
    s_lshl_b32 s42, s42, 2
    s_add_u32 s42, s42, s3
    s_lshl_b32 s43, s42, 7
    s_add_u32 s41, s41, s43
    v_and_b32 v14, 31, v0
    v_lshlrev_b32 v14, 2, v14
    v_add_u32 v14, s41, v14
    s_mov_b32 s38, 0
Lpoll_71:
    global_load_dwordx4 v[40:43], v12, s[10:11] sc1
    s_waitcnt vmcnt(0)
    v_xor_b32 v15, v40, v1
    v_bitop3_b32 v15, v41, v15, v1 bitop3:0xDE
    v_bitop3_b32 v15, v42, v15, v1 bitop3:0xDE
    v_bitop3_b32 v15, v43, v15, v1 bitop3:0xDE
    v_and_b32 v15, 0xffff, v15
    v_cmp_eq_u32 vcc, 0, v15
    s_nop 0
    s_cmp_eq_u64 vcc, exec
    s_cbranch_scc1 Lpdone_72
Lpretry_73:
    s_add_u32 s38, s38, 1
    s_cmp_lt_u32 s38, 65536
    s_cbranch_scc1 Lpoll_71
Lpdone_72:
    v_perm_b32 v40, v41, v40, s37
    v_perm_b32 v41, v43, v42, s37
    ds_write_b64 v11, v[40:41]
    s_branch Lwe_63
Lw1_62:
    s_lshl_b32 s41, s4, 14
    s_lshl_b32 s44, s6, 12
    s_add_u32 s41, s41, s44
    s_add_u32 s41, s41, 1310720
    s_lshl_b32 s42, s45, 10
    s_add_u32 s41, s41, s42
    s_and_b32 s42, s5, 1
    s_lshl_b32 s42, s42, 2
    s_add_u32 s42, s42, s3
    s_lshl_b32 s43, s42, 7
    s_add_u32 s41, s41, s43
    v_and_b32 v14, 31, v0
    v_lshlrev_b32 v14, 2, v14
    v_add_u32 v14, s41, v14
Lwe_63:
    s_waitcnt lgkmcnt(0)
    s_barrier
    ds_read_b128 v[16:19], v4 offset:1536
    ds_read_b128 v[20:23], v4 offset:1600
    ds_read_b128 v[24:27], v4 offset:1664
    ds_read_b128 v[28:31], v4 offset:1728
    s_waitcnt lgkmcnt(3)
    v_mfma_f32_16x16x32_bf16 v[56:59], v[16:19], v[80:83], 0
    s_waitcnt lgkmcnt(2)
    v_mfma_f32_16x16x32_bf16 v[56:59], v[20:23], v[84:87], v[56:59]
    s_waitcnt lgkmcnt(1)
    v_mfma_f32_16x16x32_bf16 v[56:59], v[24:27], v[88:91], v[56:59]
    s_waitcnt lgkmcnt(0)
    v_mfma_f32_16x16x32_bf16 v[56:59], v[28:31], v[92:95], v[56:59]
    s_nop 7
    v_cndmask_b32 v32, v57, v56, s[46:47]
    v_bfi_b32 v32, s35, v32, v1
    s_cmp_eq_u32 s13, 0
    s_cbranch_scc1 Lpg_74
    s_mov_b32 exec_lo, 0xffffffff
    s_mov_b32 exec_hi, 0
    global_store_dword v14, v32, s[10:11]
    s_mov_b64 exec, -1
    s_branch Lpe_75
Lpg_74:
    s_mov_b32 exec_lo, 0xffffffff
    s_mov_b32 exec_hi, 0
    global_store_dword v14, v32, s[10:11] sc1
    s_mov_b64 exec, -1
Lpe_75:
    v_lshrrev_b32 v12, 4, v0
    v_lshlrev_b32 v12, 3, v12
    v_bfe_u32 v15, v0, 2, 2
    v_add_u32 v12, v12, v15
    v_lshlrev_b32 v12, 7, v12
    v_and_b32 v15, 3, v0
    v_lshl_add_u32 v12, v15, 3, v12
    s_lshl_b32 s41, s3, 5
    s_add_u32 s41, s41, 131072
    v_add_u32 v12, s41, v12
    ds_read_b64_tr_b16 v[80:81], v12 offset:0
    ds_read_b64_tr_b16 v[82:83], v12 offset:512
    ds_read_b64_tr_b16 v[84:85], v12 offset:4096
    ds_read_b64_tr_b16 v[86:87], v12 offset:4608
    ds_read_b64_tr_b16 v[88:89], v12 offset:8192
    ds_read_b64_tr_b16 v[90:91], v12 offset:8704
    ds_read_b64_tr_b16 v[92:93], v12 offset:12288
    ds_read_b64_tr_b16 v[94:95], v12 offset:12800
    s_cmp_lg_u32 s3, 0
    s_cbranch_scc1 Lw1_76
    s_lshl_b32 s41, s4, 9
    s_add_u32 s41, s41, 270336
    v_and_b32 v12, 31, v0
    v_lshlrev_b32 v12, 4, v12
    v_add_u32 v12, s41, v12
    s_lshl_b32 s41, s4, 14
    s_lshl_b32 s44, s6, 12
    s_add_u32 s41, s41, s44
    s_add_u32 s41, s41, 1310720
    s_lshl_b32 s42, s7, 6
    s_add_u32 s41, s41, s42
    v_lshrrev_b32 v9, 3, v0
    v_lshlrev_b32 v9, 7, v9
    v_and_b32 v11, 7, v0
    v_lshl_add_u32 v9, v11, 3, v9
    v_add_u32 v9, s41, v9
    v_lshlrev_b32 v10, 3, v0
    v_add_u32 v10, 153856, v10
    ds_read_b64 v[48:49], v10
    v_lshlrev_b32 v11, 2, v0
    v_add_u32 v11, 153600, v11
    global_load_dwordx4 v[52:55], v12, s[10:11] sc1
    global_load_dwordx2 v[32:33], v9, s[10:11] offset:0 sc1
    global_load_dwordx2 v[34:35], v9, s[10:11] offset:1024 sc1
    global_load_dwordx2 v[36:37], v9, s[10:11] offset:2048 sc1
    global_load_dwordx2 v[38:39], v9, s[10:11] offset:3072 sc1
    s_waitcnt vmcnt(4)
    v_xor_b32 v52, s50, v52
    v_xor_b32 v53, s50, v53
    v_xor_b32 v54, s50, v54
    v_xor_b32 v55, s50, v55
    v_or3_b32 v15, v52, v53, v54
    v_or_b32 v15, v15, v55
    v_and_b32 v15, 0xff, v15
    v_cmp_eq_u32 vcc, 0, v15
    s_nop 0
    s_cmp_eq_u64 vcc, exec
    s_cbranch_scc1 Lok_78
    s_mov_b32 s38, 0
Lpoll_79:
    global_load_dwordx4 v[52:55], v12, s[10:11] sc1
    s_waitcnt vmcnt(0)
    v_xor_b32 v52, s50, v52
    v_xor_b32 v53, s50, v53
    v_xor_b32 v54, s50, v54
    v_xor_b32 v55, s50, v55
    v_or3_b32 v15, v52, v53, v54
    v_or_b32 v15, v15, v55
    v_and_b32 v15, 0xff, v15
    v_cmp_eq_u32 vcc, 0, v15
    s_nop 0
    s_cmp_eq_u64 vcc, exec
    s_cbranch_scc1 Lpdone_80
Lpretry_81:
    s_add_u32 s38, s38, 1
    s_cmp_lt_u32 s38, 65536
    s_cbranch_scc1 Lpoll_79
Lpdone_80:
Lok_78:
    s_cmp_eq_u32 s7, 0
    s_cbranch_scc1 Lb0_82
    v_mov_b32 v52, v54
    v_mov_b32 v53, v55
Lb0_82:
    s_nop 0
    v_add_f32_dpp v52, v52, v52 row_ror:8 row_mask:0xf bank_mask:0xf
    v_add_f32_dpp v53, v53, v53 row_ror:8 row_mask:0xf bank_mask:0xf
    s_nop 0
    v_add_f32_dpp v52, v52, v52 row_ror:4 row_mask:0xf bank_mask:0xf
    v_add_f32_dpp v53, v53, v53 row_ror:4 row_mask:0xf bank_mask:0xf
    s_nop 0
    v_add_f32_dpp v52, v52, v52 row_ror:2 row_mask:0xf bank_mask:0xf
    v_add_f32_dpp v53, v53, v53 row_ror:2 row_mask:0xf bank_mask:0xf
    s_nop 0
    v_add_f32_dpp v52, v52, v52 row_ror:1 row_mask:0xf bank_mask:0xf
    v_add_f32_dpp v53, v53, v53 row_ror:1 row_mask:0xf bank_mask:0xf
    v_mov_b32 v54, v52
    v_mov_b32 v55, v53
    s_nop 0
    v_permlane16_swap_b32 v52, v54
    v_permlane16_swap_b32 v53, v55
    v_add_f32 v52, v52, v54
    v_add_f32 v53, v53, v55
    v_mul_f32 v76, 0x3b000000, v52
    v_mul_f32 v53, 0x3b000000, v53
    v_fma_f32 v53, -v76, v76, v53
    v_max_f32 v53, 0, v53
    v_add_f32 v53, 0x3727c5ac, v53
    v_rsq_f32 v77, v53
    s_waitcnt vmcnt(0)
    v_xor_b32 v32, s50, v32
    v_xor_b32 v33, s50, v33
    v_xor_b32 v34, s50, v34
    v_xor_b32 v35, s50, v35
    v_xor_b32 v36, s50, v36
    v_xor_b32 v37, s50, v37
    v_xor_b32 v38, s50, v38
    v_xor_b32 v39, s50, v39
    v_or3_b32 v15, v32, v33, v34
    v_or3_b32 v15, v15, v35, v36
    v_or3_b32 v15, v15, v37, v38
    v_or_b32 v15, v15, v39
    v_and_b32 v15, 0xff, v15
    v_cmp_eq_u32 vcc, 0, v15
    s_nop 0
    s_cmp_eq_u64 vcc, exec
    s_cbranch_scc1 Lok_83
    s_mov_b32 s38, 0
Lpoll_84:
    global_load_dwordx2 v[32:33], v9, s[10:11] offset:0 sc1
    global_load_dwordx2 v[34:35], v9, s[10:11] offset:1024 sc1
    global_load_dwordx2 v[36:37], v9, s[10:11] offset:2048 sc1
    global_load_dwordx2 v[38:39], v9, s[10:11] offset:3072 sc1
    s_waitcnt vmcnt(0)
    v_xor_b32 v32, s50, v32
    v_xor_b32 v33, s50, v33
    v_xor_b32 v34, s50, v34
    v_xor_b32 v35, s50, v35
    v_xor_b32 v36, s50, v36
    v_xor_b32 v37, s50, v37
    v_xor_b32 v38, s50, v38
    v_xor_b32 v39, s50, v39
    v_or3_b32 v15, v32, v33, v34
    v_or3_b32 v15, v15, v35, v36
    v_or3_b32 v15, v15, v37, v38
    v_or_b32 v15, v15, v39
    v_and_b32 v15, 0xff, v15
    v_cmp_eq_u32 vcc, 0, v15
    s_nop 0
    s_cmp_eq_u64 vcc, exec
    s_cbranch_scc1 Lpdone_85
Lpretry_86:
    s_add_u32 s38, s38, 1
    s_cmp_lt_u32 s38, 65536
    s_cbranch_scc1 Lpoll_84
Lpdone_85:
Lok_83:
    v_add_f32 v32, v32, v34
    v_add_f32 v36, v36, v38
    v_add_f32 v33, v33, v35
    v_add_f32 v37, v37, v39
    v_add_f32 v32, v32, v36
    v_add_f32 v33, v33, v37
    s_waitcnt lgkmcnt(0)
    v_fma_f32 v32, -v76, v48, v32
    v_fma_f32 v33, -v76, v49, v33
    v_mul_f32 v32, v77, v32
    v_mul_f32 v33, v77, v33
    v_cvt_pk_bf16_f32 v32, v32, v33
    ds_write_b32 v11, v32
Lw1_76:
    s_waitcnt lgkmcnt(0)
    s_barrier
    ds_read_b128 v[16:19], v5 offset:0
    ds_read_b128 v[20:23], v5 offset:64
    ds_read_b128 v[24:27], v5 offset:128
    ds_read_b128 v[28:31], v5 offset:192
    s_waitcnt lgkmcnt(0)
    v_mfma_f32_16x16x32_bf16 v[32:35], a[0:3], v[16:19], 0
    v_mfma_f32_16x16x32_bf16 v[32:35], a[4:7], v[20:23], v[32:35]
    v_mfma_f32_16x16x32_bf16 v[32:35], a[8:11], v[24:27], v[32:35]
    v_mfma_f32_16x16x32_bf16 v[32:35], a[12:15], v[28:31], v[32:35]
    v_mov_b64 v[64:65], 0
    v_mfma_f32_16x16x32_bf16 v[36:39], a[16:19], v[16:19], 0
    v_mfma_f32_16x16x32_bf16 v[36:39], a[20:23], v[20:23], v[36:39]
    v_mfma_f32_16x16x32_bf16 v[36:39], a[24:27], v[24:27], v[36:39]
    v_mfma_f32_16x16x32_bf16 v[36:39], a[28:31], v[28:31], v[36:39]
    v_mov_b64 v[68:69], 0
    v_mfma_f32_16x16x32_bf16 v[40:43], a[32:35], v[16:19], 0
    v_mfma_f32_16x16x32_bf16 v[40:43], a[36:39], v[20:23], v[40:43]
    v_mfma_f32_16x16x32_bf16 v[40:43], a[40:43], v[24:27], v[40:43]
    v_mfma_f32_16x16x32_bf16 v[40:43], a[44:47], v[28:31], v[40:43]
    v_cndmask_b32 v32, v32, v34, s[56:57]
    v_cndmask_b32 v33, v33, v35, s[56:57]
    v_max_f32 v9, v32, v33
    v_mov_b64 v[72:73], 0
    v_mfma_f32_16x16x32_bf16 v[44:47], a[48:51], v[16:19], 0
    v_mfma_f32_16x16x32_bf16 v[44:47], a[52:55], v[20:23], v[44:47]
    v_mfma_f32_16x16x32_bf16 v[44:47], a[56:59], v[24:27], v[44:47]
    v_mfma_f32_16x16x32_bf16 v[44:47], a[60:63], v[28:31], v[44:47]
    v_cndmask_b32 v34, v36, v38, s[56:57]
    v_cndmask_b32 v35, v37, v39, s[56:57]
    v_max3_f32 v9, v9, v34, v35
    v_mov_b64 v[76:77], 0
    v_mfma_f32_16x16x32_bf16 v[48:51], a[64:67], v[16:19], 0
    v_mfma_f32_16x16x32_bf16 v[48:51], a[68:71], v[20:23], v[48:51]
    v_mfma_f32_16x16x32_bf16 v[48:51], a[72:75], v[24:27], v[48:51]
    v_mfma_f32_16x16x32_bf16 v[48:51], a[76:79], v[28:31], v[48:51]
    v_cndmask_b32 v36, v40, v42, s[56:57]
    v_cndmask_b32 v37, v41, v43, s[56:57]
    v_max3_f32 v9, v9, v36, v37
    v_mfma_f32_16x16x32_bf16 v[52:55], a[80:83], v[16:19], 0
    v_mfma_f32_16x16x32_bf16 v[52:55], a[84:87], v[20:23], v[52:55]
    v_mfma_f32_16x16x32_bf16 v[52:55], a[88:91], v[24:27], v[52:55]
    v_mfma_f32_16x16x32_bf16 v[52:55], a[92:95], v[28:31], v[52:55]
    v_cndmask_b32 v38, v44, v46, s[56:57]
    v_cndmask_b32 v39, v45, v47, s[56:57]
    v_max3_f32 v9, v9, v38, v39
    v_mfma_f32_16x16x32_bf16 v[56:59], a[96:99], v[16:19], 0
    v_mfma_f32_16x16x32_bf16 v[56:59], a[100:103], v[20:23], v[56:59]
    v_mfma_f32_16x16x32_bf16 v[56:59], a[104:107], v[24:27], v[56:59]
    v_mfma_f32_16x16x32_bf16 v[56:59], a[108:111], v[28:31], v[56:59]
    v_cndmask_b32 v40, v48, v50, s[56:57]
    v_cndmask_b32 v41, v49, v51, s[56:57]
    v_max3_f32 v9, v9, v40, v41
    v_mfma_f32_16x16x32_bf16 v[60:63], a[112:115], v[16:19], 0
    v_mfma_f32_16x16x32_bf16 v[60:63], a[116:119], v[20:23], v[60:63]
    v_mfma_f32_16x16x32_bf16 v[60:63], a[120:123], v[24:27], v[60:63]
    v_mfma_f32_16x16x32_bf16 v[60:63], a[124:127], v[28:31], v[60:63]
    v_cndmask_b32 v42, v52, v54, s[56:57]
    v_cndmask_b32 v43, v53, v55, s[56:57]
    v_max3_f32 v9, v9, v42, v43
    v_mov_b32 v14, 0x44444444
    v_mov_b32 v15, 0xeeeeeeee
    v_cndmask_b32 v14, v14, v15, s[56:57]
    v_cndmask_b32 v44, v56, v58, s[56:57]
    v_cndmask_b32 v45, v57, v59, s[56:57]
    v_max3_f32 v9, v9, v44, v45
    v_cndmask_b32 v46, v60, v62, s[56:57]
    v_cndmask_b32 v47, v61, v63, s[56:57]
    v_max3_f32 v9, v9, v46, v47
    s_nop 1
    v_max_f32_dpp v9, v9, v9 quad_perm:[1,0,3,2] row_mask:0xf bank_mask:0xf
    v_mov_b32 v10, v9
    s_nop 1
    v_permlane16_swap_b32 v9, v10
    v_max_f32 v9, v9, v10
    v_mov_b32 v10, v9
    s_nop 1
    v_permlane32_swap_b32 v9, v10
    v_max_f32 v9, v9, v10
    v_mul_f32 v12, s34, v9
    v_mov_b64 v[16:17], 0
    v_mov_b64 v[20:21], 0
    v_mov_b64 v[24:25], 0
    v_mov_b64 v[28:29], 0
    v_fma_f32 v32, v32, s34, -v12
    v_fma_f32 v33, v33, s34, -v12
    v_fma_f32 v34, v34, s34, -v12
    v_fma_f32 v35, v35, s34, -v12
    v_fma_f32 v36, v36, s34, -v12
    v_fma_f32 v37, v37, s34, -v12
    v_fma_f32 v38, v38, s34, -v12
    v_fma_f32 v39, v39, s34, -v12
    v_exp_f32 v32, v32
    v_exp_f32 v33, v33
    v_exp_f32 v34, v34
    v_exp_f32 v35, v35
    v_exp_f32 v36, v36
    v_exp_f32 v37, v37
    v_exp_f32 v38, v38
    v_exp_f32 v39, v39
    v_cvt_pk_bf16_f32 v48, v32, v33
    v_cvt_pk_bf16_f32 v49, v34, v35
    v_cvt_pk_bf16_f32 v50, v36, v37
    v_cvt_pk_bf16_f32 v51, v38, v39
    s_nop 1
    v_smfmac_f32_16x16x64_bf16 v[64:67], v[48:51], a[128:135], v14
    v_fma_f32 v40, v40, s34, -v12
    v_fma_f32 v41, v41, s34, -v12
    v_smfmac_f32_16x16x64_bf16 v[68:71], v[48:51], a[144:151], v14
    v_fma_f32 v42, v42, s34, -v12
    v_fma_f32 v43, v43, s34, -v12
    v_fma_f32 v44, v44, s34, -v12
    v_smfmac_f32_16x16x64_bf16 v[72:75], v[48:51], a[160:167], v14
    v_fma_f32 v45, v45, s34, -v12
    v_fma_f32 v46, v46, s34, -v12
    v_smfmac_f32_16x16x64_bf16 v[76:79], v[48:51], a[176:183], v14
    v_fma_f32 v47, v47, s34, -v12
    v_exp_f32 v40, v40
    v_exp_f32 v41, v41
    v_smfmac_f32_16x16x64_bf16 v[16:19], v[48:51], a[192:199], v14
    v_exp_f32 v42, v42
    v_exp_f32 v43, v43
    v_smfmac_f32_16x16x64_bf16 v[20:23], v[48:51], a[208:215], v14
    v_exp_f32 v44, v44
    v_exp_f32 v45, v45
    v_exp_f32 v46, v46
    v_smfmac_f32_16x16x64_bf16 v[24:27], v[48:51], a[224:231], v14
    v_exp_f32 v47, v47
    v_cvt_pk_bf16_f32 v52, v40, v41
    v_smfmac_f32_16x16x64_bf16 v[28:31], v[48:51], a[240:247], v14
    v_cvt_pk_bf16_f32 v53, v42, v43
    v_cvt_pk_bf16_f32 v54, v44, v45
    v_cvt_pk_bf16_f32 v55, v46, v47
    s_nop 1
    v_smfmac_f32_16x16x64_bf16 v[64:67], v[52:55], a[136:143], v14
    v_add_f32 v13, v32, v33
    v_add_f32 v15, v40, v41
    v_smfmac_f32_16x16x64_bf16 v[68:71], v[52:55], a[152:159], v14
    v_add_f32 v13, v13, v34
    v_add_f32 v15, v15, v42
    v_add_f32 v13, v13, v35
    v_smfmac_f32_16x16x64_bf16 v[72:75], v[52:55], a[168:175], v14
    v_add_f32 v15, v15, v43
    v_add_f32 v13, v13, v36
    v_add_f32 v15, v15, v44
    v_smfmac_f32_16x16x64_bf16 v[76:79], v[52:55], a[184:191], v14
    v_add_f32 v13, v13, v37
    v_add_f32 v15, v15, v45
    v_add_f32 v13, v13, v38
    v_smfmac_f32_16x16x64_bf16 v[16:19], v[52:55], a[200:207], v14
    v_add_f32 v15, v15, v46
    v_add_f32 v13, v13, v39
    v_smfmac_f32_16x16x64_bf16 v[20:23], v[52:55], a[216:223], v14
    v_add_f32 v15, v15, v47
    v_add_f32 v13, v13, v15
    s_nop 1
    v_add_f32_dpp v13, v13, v13 quad_perm:[1,0,3,2] row_mask:0xf bank_mask:0xf
    v_smfmac_f32_16x16x64_bf16 v[24:27], v[52:55], a[232:239], v14
    v_mov_b32 v10, v13
    s_nop 1
    v_permlane16_swap_b32 v13, v10
    v_add_f32 v13, v13, v10
    v_smfmac_f32_16x16x64_bf16 v[28:31], v[52:55], a[248:255], v14
    v_mov_b32 v10, v13
    s_nop 1
    v_permlane32_swap_b32 v13, v10
    v_add_f32 v13, v13, v10
    v_and_b32 v9, 15, v0
    v_lshlrev_b32 v9, 2, v9
    s_lshl_b32 s41, s3, 9
    s_add_u32 s41, s41, 147456
    v_add_u32 v9, s41, v9
    s_lshl_b32 s41, s3, 3
    s_add_u32 s41, s41, 149504
    v_mov_b32 v10, s41
    s_mov_b32 exec_lo, 0xffff
    s_mov_b32 exec_hi, 0
    v_add_f32 v64, v64, v65
    v_add_f32 v68, v68, v69
    ds_write2_b32 v9, v64, v68 offset0:0 offset1:16
    v_add_f32 v72, v72, v73
    v_add_f32 v76, v76, v77
    ds_write2_b32 v9, v72, v76 offset0:32 offset1:48
    v_add_f32 v16, v16, v17
    v_add_f32 v20, v20, v21
    ds_write2_b32 v9, v16, v20 offset0:64 offset1:80
    v_add_f32 v24, v24, v25
    v_add_f32 v28, v28, v29
    ds_write2_b32 v9, v24, v28 offset0:96 offset1:112
    s_mov_b64 exec, 1
    ds_write_b64 v10, v[12:13]
    s_mov_b64 exec, -1
    s_waitcnt lgkmcnt(0)
    s_barrier
    s_cmp_lg_u32 s3, 0
    s_cbranch_scc1 Lw1_87
    v_lshlrev_b32 v9, 3, v0
    v_add_u32 v10, 147456, v9
    v_mov_b32 v11, 149504
    ds_read_b128 v[48:51], v11
    ds_read_b128 v[52:55], v11 offset:16
    ds_read_b64 v[32:33], v10 offset:0
    ds_read_b64 v[34:35], v10 offset:512
    ds_read_b64 v[36:37], v10 offset:1024
    ds_read_b64 v[38:39], v10 offset:1536
    s_lshl_b32 s41, s4, 15
    s_lshl_b32 s42, s5, 10
    s_add_u32 s41, s41, s42
    s_add_u32 s41, s41, 2621440
    v_add_u32 v9, s41, v9
    v_mov_b32 v10, s41
    s_waitcnt lgkmcnt(4)
    v_max3_f32 v56, v48, v50, v52
    v_mov_b32 v58, v1
    v_max_f32 v56, v56, v54
    v_mov_b32 v59, v1
    v_sub_f32 v48, v48, v56
    v_sub_f32 v50, v50, v56
    v_sub_f32 v52, v52, v56
    v_sub_f32 v54, v54, v56
    v_exp_f32 v48, v48
    v_exp_f32 v50, v50
    v_exp_f32 v52, v52
    v_exp_f32 v54, v54
    s_waitcnt lgkmcnt(0)
    v_mul_f32 v32, v48, v32
    v_mul_f32 v33, v48, v33
    v_mul_f32 v57, v48, v49
    v_fmac_f32 v32, v50, v34
    v_fmac_f32 v33, v50, v35
    v_fmac_f32 v57, v50, v51
    v_fmac_f32 v32, v52, v36
    v_fmac_f32 v33, v52, v37
    v_fmac_f32 v57, v52, v53
    v_fmac_f32 v32, v54, v38
    v_fmac_f32 v33, v54, v39
    v_fmac_f32 v57, v54, v55
    v_bfi_b32 v32, s35, v32, v1
    v_bfi_b32 v33, s35, v33, v1
    s_cmp_eq_u32 s13, 0
    s_cbranch_scc1 Lpg_89
    global_store_dwordx2 v9, v[32:33], s[10:11]
    s_mov_b64 exec, 1
    global_store_dwordx4 v10, v[56:59], s[10:11] offset:512
    s_mov_b64 exec, -1
    s_branch Lpe_90
Lpg_89:
    global_store_dwordx2 v9, v[32:33], s[10:11] sc1
    s_mov_b64 exec, 1
    global_store_dwordx4 v10, v[56:59], s[10:11] offset:512 sc1
    s_mov_b64 exec, -1
Lpe_90:
    s_lshr_b32 s41, s5, 2
    s_lshl_b32 s41, s41, 2
    s_add_u32 s41, s41, s3
    s_lshl_b32 s41, s41, 12
    s_lshl_b32 s42, s4, 2
    s_add_u32 s42, s42, s9
    s_lshl_b32 s42, s42, 7
    s_add_u32 s41, s41, s42
    s_add_u32 s41, s41, 786432
    v_and_b32 v14, 31, v0
    v_lshlrev_b32 v14, 2, v14
    v_add_u32 v14, s41, v14
    v_mov_b32 v56, v2
    v_xor_b32 v57, 32, v2
    v_xor_b32 v58, 64, v2
    v_xor_b32 v59, 96, v2
    v_xor_b32 v60, 128, v2
    v_xor_b32 v61, 160, v2
    v_xor_b32 v62, 192, v2
    v_xor_b32 v63, 224, v2
    ds_read_b64_tr_b16 a[128:129], v56 offset:0
    ds_read_b64_tr_b16 a[130:131], v56 offset:4096
    ds_read_b64_tr_b16 a[132:133], v56 offset:2048
    ds_read_b64_tr_b16 a[134:135], v56 offset:6144
    ds_read_b64_tr_b16 a[144:145], v57 offset:0
    ds_read_b64_tr_b16 a[146:147], v57 offset:4096
    ds_read_b64_tr_b16 a[148:149], v57 offset:2048
    ds_read_b64_tr_b16 a[150:151], v57 offset:6144
    ds_read_b64_tr_b16 a[160:161], v58 offset:0
    ds_read_b64_tr_b16 a[162:163], v58 offset:4096
    ds_read_b64_tr_b16 a[164:165], v58 offset:2048
    ds_read_b64_tr_b16 a[166:167], v58 offset:6144
    ds_read_b64_tr_b16 a[176:177], v59 offset:0
    ds_read_b64_tr_b16 a[178:179], v59 offset:4096
    ds_read_b64_tr_b16 a[180:181], v59 offset:2048
    ds_read_b64_tr_b16 a[182:183], v59 offset:6144
    ds_read_b64_tr_b16 a[192:193], v60 offset:0
    ds_read_b64_tr_b16 a[194:195], v60 offset:4096
    ds_read_b64_tr_b16 a[196:197], v60 offset:2048
    ds_read_b64_tr_b16 a[198:199], v60 offset:6144
    ds_read_b64_tr_b16 a[208:209], v61 offset:0
    ds_read_b64_tr_b16 a[210:211], v61 offset:4096
    ds_read_b64_tr_b16 a[212:213], v61 offset:2048
    ds_read_b64_tr_b16 a[214:215], v61 offset:6144
    ds_read_b64_tr_b16 a[224:225], v62 offset:0
    ds_read_b64_tr_b16 a[226:227], v62 offset:4096
    ds_read_b64_tr_b16 a[228:229], v62 offset:2048
    ds_read_b64_tr_b16 a[230:231], v62 offset:6144
    ds_read_b64_tr_b16 a[240:241], v63 offset:0
    ds_read_b64_tr_b16 a[242:243], v63 offset:4096
    ds_read_b64_tr_b16 a[244:245], v63 offset:2048
    ds_read_b64_tr_b16 a[246:247], v63 offset:6144
    v_lshrrev_b32 v9, 5, v0
    v_lshlrev_b32 v9, 12, v9
    s_lshl_b32 s41, s4, 15
    s_lshl_b32 s42, s9, 13
    s_add_u32 s41, s41, s42
    s_add_u32 s41, s41, 2621440
    v_add_u32 v9, s41, v9
    v_and_b32 v10, 3, v0
    v_lshl_add_u32 v10, v10, 10, v9
    v_and_b32 v11, 31, v0
    v_lshl_add_u32 v9, v11, 4, v9
    v_lshlrev_b32 v11, 3, v11
    v_lshrrev_b32 v15, 5, v0
    v_mul_u32_u24 v15, 320, v15
    v_add_u32 v11, v11, v15
    v_add_u32 v11, 150528, v11
    s_mov_b32 s38, 0
Lpoll_91:
    global_load_dwordx4 v[32:35], v9, s[10:11] offset:0 sc1
    global_load_dwordx4 v[36:39], v9, s[10:11] offset:1024 sc1
    global_load_dwordx4 v[40:43], v9, s[10:11] offset:2048 sc1
    global_load_dwordx4 v[44:47], v9, s[10:11] offset:3072 sc1
    global_load_dwordx4 v[48:51], v10, s[10:11] offset:512 sc1
    s_waitcnt vmcnt(0)
    v_xor_b32 v32, s50, v32
    v_xor_b32 v33, s50, v33
    v_xor_b32 v34, s50, v34
    v_xor_b32 v35, s50, v35
    v_xor_b32 v36, s50, v36
    v_xor_b32 v37, s50, v37
    v_xor_b32 v38, s50, v38
    v_xor_b32 v39, s50, v39
    v_xor_b32 v40, s50, v40
    v_xor_b32 v41, s50, v41
    v_xor_b32 v42, s50, v42
    v_xor_b32 v43, s50, v43
    v_xor_b32 v44, s50, v44
    v_xor_b32 v45, s50, v45
    v_xor_b32 v46, s50, v46
    v_xor_b32 v47, s50, v47
    v_or3_b32 v15, v32, v33, v34
    v_or3_b32 v15, v15, v35, v36
    v_or3_b32 v15, v15, v37, v38
    v_or3_b32 v15, v15, v39, v40
    v_or3_b32 v15, v15, v41, v42
    v_or3_b32 v15, v15, v43, v44
    v_or3_b32 v15, v15, v45, v46
    v_or_b32 v15, v15, v47
    v_and_b32 v15, 0xff, v15
    v_bitop3_b32 v15, v50, v15, v1 bitop3:0xDE
    v_bitop3_b32 v15, v51, v15, v1 bitop3:0xDE
    v_cmp_eq_u32 vcc, 0, v15
    s_nop 0
    s_cmp_eq_u64 vcc, exec
    s_cbranch_scc1 Lpdone_92
Lpretry_93:
    s_add_u32 s38, s38, 1
    s_cmp_lt_u32 s38, 65536
    s_cbranch_scc1 Lpoll_91
Lpdone_92:
    v_max_f32_dpp v9, v48, v48 quad_perm:[1,0,3,2] row_mask:0xf bank_mask:0xf
    s_nop 1
    v_max_f32_dpp v9, v9, v9 quad_perm:[2,3,0,1] row_mask:0xf bank_mask:0xf
    v_sub_f32 v48, v48, v9
    v_exp_f32 v48, v48
    s_nop 0
    v_mul_f32 v49, v48, v49
    s_nop 1
    v_add_f32_dpp v9, v49, v49 quad_perm:[1,0,3,2] row_mask:0xf bank_mask:0xf
    s_nop 1
    v_add_f32_dpp v9, v9, v9 quad_perm:[2,3,0,1] row_mask:0xf bank_mask:0xf
    v_rcp_f32 v9, v9
    s_nop 0
    v_mul_f32 v48, v48, v9
    s_nop 1
    v_mul_f32_dpp v52, v48, v32 quad_perm:[0,0,0,0] row_mask:0xf bank_mask:0xf
    v_mul_f32_dpp v53, v48, v33 quad_perm:[0,0,0,0] row_mask:0xf bank_mask:0xf
    v_mul_f32_dpp v54, v48, v34 quad_perm:[0,0,0,0] row_mask:0xf bank_mask:0xf
    v_mul_f32_dpp v55, v48, v35 quad_perm:[0,0,0,0] row_mask:0xf bank_mask:0xf
    v_fmac_f32_dpp v52, v48, v36 quad_perm:[1,1,1,1] row_mask:0xf bank_mask:0xf
    v_fmac_f32_dpp v53, v48, v37 quad_perm:[1,1,1,1] row_mask:0xf bank_mask:0xf
    v_fmac_f32_dpp v54, v48, v38 quad_perm:[1,1,1,1] row_mask:0xf bank_mask:0xf
    v_fmac_f32_dpp v55, v48, v39 quad_perm:[1,1,1,1] row_mask:0xf bank_mask:0xf
    v_fmac_f32_dpp v52, v48, v40 quad_perm:[2,2,2,2] row_mask:0xf bank_mask:0xf
    v_fmac_f32_dpp v53, v48, v41 quad_perm:[2,2,2,2] row_mask:0xf bank_mask:0xf
    v_fmac_f32_dpp v54, v48, v42 quad_perm:[2,2,2,2] row_mask:0xf bank_mask:0xf
    v_fmac_f32_dpp v55, v48, v43 quad_perm:[2,2,2,2] row_mask:0xf bank_mask:0xf
    v_fmac_f32_dpp v52, v48, v44 quad_perm:[3,3,3,3] row_mask:0xf bank_mask:0xf
    v_fmac_f32_dpp v53, v48, v45 quad_perm:[3,3,3,3] row_mask:0xf bank_mask:0xf
    v_fmac_f32_dpp v54, v48, v46 quad_perm:[3,3,3,3] row_mask:0xf bank_mask:0xf
    v_fmac_f32_dpp v55, v48, v47 quad_perm:[3,3,3,3] row_mask:0xf bank_mask:0xf
    v_cvt_pk_bf16_f32 v52, v52, v53
    v_cvt_pk_bf16_f32 v53, v54, v55
    ds_write_b64 v11, v[52:53]
    s_branch Lwe_88
Lw1_87:
    s_lshr_b32 s41, s5, 2
    s_lshl_b32 s41, s41, 2
    s_add_u32 s41, s41, s3
    s_lshl_b32 s41, s41, 12
    s_lshl_b32 s42, s4, 2
    s_add_u32 s42, s42, s9
    s_lshl_b32 s42, s42, 7
    s_add_u32 s41, s41, s42
    s_add_u32 s41, s41, 786432
    v_and_b32 v14, 31, v0
    v_lshlrev_b32 v14, 2, v14
    v_add_u32 v14, s41, v14
Lwe_88:
    s_waitcnt lgkmcnt(0)
    s_barrier
    ds_read_b128 v[16:19], v4 offset:0
    ds_read_b128 v[20:23], v4 offset:64
    ds_read_b128 v[24:27], v4 offset:128
    ds_read_b128 v[28:31], v4 offset:192
    s_waitcnt lgkmcnt(3)
    v_mfma_f32_16x16x32_bf16 v[56:59], v[16:19], v[96:99], 0
    s_waitcnt lgkmcnt(2)
    v_mfma_f32_16x16x32_bf16 v[56:59], v[20:23], v[100:103], v[56:59]
    s_waitcnt lgkmcnt(1)
    v_mfma_f32_16x16x32_bf16 v[56:59], v[24:27], v[104:107], v[56:59]
    s_waitcnt lgkmcnt(0)
    v_mfma_f32_16x16x32_bf16 v[56:59], v[28:31], v[108:111], v[56:59]
    s_nop 7
    v_cndmask_b32 v32, v57, v56, s[46:47]
    v_bfi_b32 v32, s35, v32, v1
    s_mov_b32 exec_lo, 0xffffffff
    s_mov_b32 exec_hi, 0
    global_store_dword v14, v32, s[10:11] sc1
    s_mov_b64 exec, -1
    s_cmp_lg_u32 s3, 0
    s_cbranch_scc1 Lw1_94
    s_lshl_b32 s41, s5, 12
    s_add_u32 s41, s41, 786432
    v_lshlrev_b32 v13, 4, v0
    v_add_u32 v13, s41, v13
    v_and_b32 v9, 7, v0
    v_lshrrev_b32 v10, 4, v0
    v_lshl_add_u32 v9, v9, 2, v10
    v_lshlrev_b32 v9, 2, v9
    s_lshl_b32 s41, s4, 12
    s_lshl_b32 s42, s5, 7
    s_add_u32 s41, s41, s42
    s_add_u32 s41, s41, 163840
    v_add_u32 v9, s41, v9
    s_lshl_b32 s41, s4, 9
    s_lshl_b32 s42, s5, 4
    s_add_u32 s41, s41, s42
    s_add_u32 s41, s41, 274432
    v_bfe_u32 v10, v0, 2, 1
    v_lshlrev_b32 v10, 3, v10
    v_add_u32 v10, s41, v10
    s_lshl_b32 s41, s4, 12
    s_lshl_b32 s42, s45, 10
    s_add_u32 s41, s41, s42
    s_add_u32 s41, s41, 163840
    v_lshlrev_b32 v12, 4, v0
    v_add_u32 v12, s41, v12
    v_bfe_u32 v11, v0, 2, 1
    v_mul_u32_u24 v11, 320, v11
    v_lshrrev_b32 v15, 3, v0
    v_lshl_add_u32 v11, v15, 5, v11
    v_and_b32 v15, 3, v0
    v_lshl_add_u32 v11, v15, 3, v11
    v_add_u32 v11, 152064, v11
    v_mov_b32 v56, v2
    v_xor_b32 v57, 32, v2
    v_xor_b32 v58, 64, v2
    v_xor_b32 v59, 96, v2
    v_xor_b32 v60, 128, v2
    v_xor_b32 v61, 160, v2
    v_xor_b32 v62, 192, v2
    v_xor_b32 v63, 224, v2
    ds_read_b64_tr_b16 a[136:137], v56 offset:16384
    ds_read_b64_tr_b16 a[138:139], v56 offset:20480
    ds_read_b64_tr_b16 a[140:141], v56 offset:18432
    ds_read_b64_tr_b16 a[142:143], v56 offset:22528
    ds_read_b64_tr_b16 a[152:153], v57 offset:16384
    ds_read_b64_tr_b16 a[154:155], v57 offset:20480
    ds_read_b64_tr_b16 a[156:157], v57 offset:18432
    ds_read_b64_tr_b16 a[158:159], v57 offset:22528
    ds_read_b64_tr_b16 a[168:169], v58 offset:16384
    ds_read_b64_tr_b16 a[170:171], v58 offset:20480
    ds_read_b64_tr_b16 a[172:173], v58 offset:18432
    ds_read_b64_tr_b16 a[174:175], v58 offset:22528
    ds_read_b64_tr_b16 a[184:185], v59 offset:16384
    ds_read_b64_tr_b16 a[186:187], v59 offset:20480
    ds_read_b64_tr_b16 a[188:189], v59 offset:18432
    ds_read_b64_tr_b16 a[190:191], v59 offset:22528
    ds_read_b64_tr_b16 a[200:201], v60 offset:16384
    ds_read_b64_tr_b16 a[202:203], v60 offset:20480
    ds_read_b64_tr_b16 a[204:205], v60 offset:18432
    ds_read_b64_tr_b16 a[206:207], v60 offset:22528
    ds_read_b64_tr_b16 a[216:217], v61 offset:16384
    ds_read_b64_tr_b16 a[218:219], v61 offset:20480
    ds_read_b64_tr_b16 a[220:221], v61 offset:18432
    ds_read_b64_tr_b16 a[222:223], v61 offset:22528
    ds_read_b64_tr_b16 a[232:233], v62 offset:16384
    ds_read_b64_tr_b16 a[234:235], v62 offset:20480
    ds_read_b64_tr_b16 a[236:237], v62 offset:18432
    ds_read_b64_tr_b16 a[238:239], v62 offset:22528
    ds_read_b64_tr_b16 a[248:249], v63 offset:16384
    ds_read_b64_tr_b16 a[250:251], v63 offset:20480
    ds_read_b64_tr_b16 a[252:253], v63 offset:18432
    ds_read_b64_tr_b16 a[254:255], v63 offset:22528
    s_mov_b32 s38, 0
    s_sleep 6
Lpoll_96:
    global_load_dwordx4 v[32:35], v13, s[10:11] offset:0 sc1
    global_load_dwordx4 v[36:39], v13, s[10:11] offset:1024 sc1
    global_load_dwordx4 v[40:43], v13, s[10:11] offset:2048 sc1
    global_load_dwordx4 v[44:47], v13, s[10:11] offset:3072 sc1
    s_waitcnt vmcnt(0)
    v_xor_b32 v32, s50, v32
    v_xor_b32 v33, s50, v33
    v_xor_b32 v34, s50, v34
    v_xor_b32 v35, s50, v35
    v_xor_b32 v36, s50, v36
    v_xor_b32 v37, s50, v37
    v_xor_b32 v38, s50, v38
    v_xor_b32 v39, s50, v39
    v_xor_b32 v40, s50, v40
    v_xor_b32 v41, s50, v41
    v_xor_b32 v42, s50, v42
    v_xor_b32 v43, s50, v43
    v_xor_b32 v44, s50, v44
    v_xor_b32 v45, s50, v45
    v_xor_b32 v46, s50, v46
    v_xor_b32 v47, s50, v47
    v_or3_b32 v15, v32, v33, v34
    v_or3_b32 v15, v15, v35, v36
    v_or3_b32 v15, v15, v37, v38
    v_or3_b32 v15, v15, v39, v40
    v_or3_b32 v15, v15, v41, v42
    v_or3_b32 v15, v15, v43, v44
    v_or3_b32 v15, v15, v45, v46
    v_or_b32 v15, v15, v47
    v_and_b32 v15, 0xff, v15
    v_cmp_eq_u32 vcc, 0, v15
    s_nop 0
    s_cmp_eq_u64 vcc, exec
    s_cbranch_scc1 Lpdone_97
Lpretry_98:
    s_add_u32 s38, s38, 1
    s_cmp_lt_u32 s38, 65536
    s_cbranch_scc1 Lpoll_96
Lpdone_97:
    v_add_f32 v32, v32, v36
    v_add_f32 v40, v40, v44
    v_add_f32 v33, v33, v37
    v_add_f32 v41, v41, v45
    v_add_f32 v34, v34, v38
    v_add_f32 v42, v42, v46
    v_add_f32 v35, v35, v39
    v_add_f32 v43, v43, v47
    v_add_f32 v32, v32, v40
    v_add_f32 v33, v33, v41
    v_add_f32 v34, v34, v42
    v_add_f32 v35, v35, v43
    v_add_f32_dpp v32, v32, v32 row_ror:8 row_mask:0xf bank_mask:0xf
    v_add_f32_dpp v33, v33, v33 row_ror:8 row_mask:0xf bank_mask:0xf
    v_add_f32_dpp v34, v34, v34 row_ror:8 row_mask:0xf bank_mask:0xf
    v_add_f32_dpp v35, v35, v35 row_ror:8 row_mask:0xf bank_mask:0xf
    v_permlane16_swap_b32 v32, v33
    s_nop 0
    v_permlane16_swap_b32 v34, v35
    v_add_f32 v32, v32, v33
    v_add_f32 v34, v34, v35
    s_nop 1
    v_permlane32_swap_b32 v32, v34
    v_add_f32 v32, v32, v34
    v_cvt_pk_bf16_f32 v32, v32, v32
    v_and_b32 v32, 0xffff0000, v32
    v_add_f32 v32, v3, v32
    v_cvt_pk_bf16_f32 v32, v32, v32
    v_and_b32 v3, 0xffff0000, v32
    v_bfi_b32 v32, s36, v3, v1
    s_mov_b32 exec_lo, 0xff00ff
    s_mov_b32 exec_hi, 0xff00ff
    s_cmp_eq_u32 s13, 0
    s_cbranch_scc1 Lpg_99
    global_store_dword v9, v32, s[10:11]
    s_branch Lpe_100
Lpg_99:
    global_store_dword v9, v32, s[10:11] sc1
Lpe_100:
    s_mov_b64 exec, -1
    v_mul_f32 v37, v3, v3
    v_add_f32_dpp v36, v3, v3 quad_perm:[1,0,3,2] row_mask:0xf bank_mask:0xf
    s_nop 0
    v_add_f32_dpp v37, v37, v37 quad_perm:[1,0,3,2] row_mask:0xf bank_mask:0xf
    v_add_f32_dpp v36, v36, v36 quad_perm:[2,3,0,1] row_mask:0xf bank_mask:0xf
    s_nop 0
    v_add_f32_dpp v37, v37, v37 quad_perm:[2,3,0,1] row_mask:0xf bank_mask:0xf
    v_mov_b32 v38, v36
    v_mov_b32 v39, v37
    s_nop 0
    v_permlane16_swap_b32 v36, v38
    v_permlane16_swap_b32 v37, v39
    v_add_f32 v36, v36, v38
    v_add_f32 v37, v37, v39
    v_mov_b32 v38, v36
    v_mov_b32 v39, v37
    s_nop 0
    v_permlane32_swap_b32 v36, v38
    v_permlane32_swap_b32 v37, v39
    v_add_f32 v36, v36, v38
    v_add_f32 v37, v37, v39
    v_bfi_b32 v36, s35, v36, v1
    v_bfi_b32 v37, s35, v37, v1
    s_mov_b64 exec, 17
    s_cmp_eq_u32 s13, 0
    s_cbranch_scc1 Lpg_101
    global_store_dwordx2 v10, v[36:37], s[10:11]
    s_branch Lpe_102
Lpg_101:
    global_store_dwordx2 v10, v[36:37], s[10:11] sc1
Lpe_102:
    s_mov_b64 exec, -1
    s_lshl_b32 s41, s4, 14
    s_lshl_b32 s44, s6, 12
    s_add_u32 s41, s41, s44
    s_add_u32 s41, s41, 1441792
    s_lshl_b32 s42, s45, 10
    s_add_u32 s41, s41, s42
    s_and_b32 s42, s5, 1
    s_lshl_b32 s42, s42, 2
    s_add_u32 s42, s42, s3
    s_lshl_b32 s43, s42, 7
    s_add_u32 s41, s41, s43
    v_and_b32 v14, 31, v0
    v_lshlrev_b32 v14, 2, v14
    v_add_u32 v14, s41, v14
    s_mov_b32 s38, 0
Lpoll_103:
    global_load_dwordx4 v[40:43], v12, s[10:11] sc1
    s_waitcnt vmcnt(0)
    v_xor_b32 v15, v40, v1
    v_bitop3_b32 v15, v41, v15, v1 bitop3:0xDE
    v_bitop3_b32 v15, v42, v15, v1 bitop3:0xDE
    v_bitop3_b32 v15, v43, v15, v1 bitop3:0xDE
    v_and_b32 v15, 0xffff, v15
    v_cmp_eq_u32 vcc, 0, v15
    s_nop 0
    s_cmp_eq_u64 vcc, exec
    s_cbranch_scc1 Lpdone_104
Lpretry_105:
    s_add_u32 s38, s38, 1
    s_cmp_lt_u32 s38, 65536
    s_cbranch_scc1 Lpoll_103
Lpdone_104:
    v_perm_b32 v40, v41, v40, s37
    v_perm_b32 v41, v43, v42, s37
    ds_write_b64 v11, v[40:41]
    s_branch Lwe_95
Lw1_94:
    s_lshl_b32 s41, s4, 14
    s_lshl_b32 s44, s6, 12
    s_add_u32 s41, s41, s44
    s_add_u32 s41, s41, 1441792
    s_lshl_b32 s42, s45, 10
    s_add_u32 s41, s41, s42
    s_and_b32 s42, s5, 1
    s_lshl_b32 s42, s42, 2
    s_add_u32 s42, s42, s3
    s_lshl_b32 s43, s42, 7
    s_add_u32 s41, s41, s43
    v_and_b32 v14, 31, v0
    v_lshlrev_b32 v14, 2, v14
    v_add_u32 v14, s41, v14
    v_mov_b32 v56, v2
    v_xor_b32 v57, 32, v2
    v_xor_b32 v58, 64, v2
    v_xor_b32 v59, 96, v2
    v_xor_b32 v60, 128, v2
    v_xor_b32 v61, 160, v2
    v_xor_b32 v62, 192, v2
    v_xor_b32 v63, 224, v2
    ds_read_b64_tr_b16 a[128:129], v56 offset:0
    ds_read_b64_tr_b16 a[130:131], v56 offset:4096
    ds_read_b64_tr_b16 a[132:133], v56 offset:2048
    ds_read_b64_tr_b16 a[134:135], v56 offset:6144
    ds_read_b64_tr_b16 a[144:145], v57 offset:0
    ds_read_b64_tr_b16 a[146:147], v57 offset:4096
    ds_read_b64_tr_b16 a[148:149], v57 offset:2048
    ds_read_b64_tr_b16 a[150:151], v57 offset:6144
    ds_read_b64_tr_b16 a[160:161], v58 offset:0
    ds_read_b64_tr_b16 a[162:163], v58 offset:4096
    ds_read_b64_tr_b16 a[164:165], v58 offset:2048
    ds_read_b64_tr_b16 a[166:167], v58 offset:6144
    ds_read_b64_tr_b16 a[176:177], v59 offset:0
    ds_read_b64_tr_b16 a[178:179], v59 offset:4096
    ds_read_b64_tr_b16 a[180:181], v59 offset:2048
    ds_read_b64_tr_b16 a[182:183], v59 offset:6144
    ds_read_b64_tr_b16 a[192:193], v60 offset:0
    ds_read_b64_tr_b16 a[194:195], v60 offset:4096
    ds_read_b64_tr_b16 a[196:197], v60 offset:2048
    ds_read_b64_tr_b16 a[198:199], v60 offset:6144
    ds_read_b64_tr_b16 a[208:209], v61 offset:0
    ds_read_b64_tr_b16 a[210:211], v61 offset:4096
    ds_read_b64_tr_b16 a[212:213], v61 offset:2048
    ds_read_b64_tr_b16 a[214:215], v61 offset:6144
    ds_read_b64_tr_b16 a[224:225], v62 offset:0
    ds_read_b64_tr_b16 a[226:227], v62 offset:4096
    ds_read_b64_tr_b16 a[228:229], v62 offset:2048
    ds_read_b64_tr_b16 a[230:231], v62 offset:6144
    ds_read_b64_tr_b16 a[240:241], v63 offset:0
    ds_read_b64_tr_b16 a[242:243], v63 offset:4096
    ds_read_b64_tr_b16 a[244:245], v63 offset:2048
    ds_read_b64_tr_b16 a[246:247], v63 offset:6144
    ds_read_b64_tr_b16 a[136:137], v56 offset:16384
    ds_read_b64_tr_b16 a[138:139], v56 offset:20480
    ds_read_b64_tr_b16 a[140:141], v56 offset:18432
    ds_read_b64_tr_b16 a[142:143], v56 offset:22528
    ds_read_b64_tr_b16 a[152:153], v57 offset:16384
    ds_read_b64_tr_b16 a[154:155], v57 offset:20480
    ds_read_b64_tr_b16 a[156:157], v57 offset:18432
    ds_read_b64_tr_b16 a[158:159], v57 offset:22528
    ds_read_b64_tr_b16 a[168:169], v58 offset:16384
    ds_read_b64_tr_b16 a[170:171], v58 offset:20480
    ds_read_b64_tr_b16 a[172:173], v58 offset:18432
    ds_read_b64_tr_b16 a[174:175], v58 offset:22528
    ds_read_b64_tr_b16 a[184:185], v59 offset:16384
    ds_read_b64_tr_b16 a[186:187], v59 offset:20480
    ds_read_b64_tr_b16 a[188:189], v59 offset:18432
    ds_read_b64_tr_b16 a[190:191], v59 offset:22528
    ds_read_b64_tr_b16 a[200:201], v60 offset:16384
    ds_read_b64_tr_b16 a[202:203], v60 offset:20480
    ds_read_b64_tr_b16 a[204:205], v60 offset:18432
    ds_read_b64_tr_b16 a[206:207], v60 offset:22528
    ds_read_b64_tr_b16 a[216:217], v61 offset:16384
    ds_read_b64_tr_b16 a[218:219], v61 offset:20480
    ds_read_b64_tr_b16 a[220:221], v61 offset:18432
    ds_read_b64_tr_b16 a[222:223], v61 offset:22528
    ds_read_b64_tr_b16 a[232:233], v62 offset:16384
    ds_read_b64_tr_b16 a[234:235], v62 offset:20480
    ds_read_b64_tr_b16 a[236:237], v62 offset:18432
    ds_read_b64_tr_b16 a[238:239], v62 offset:22528
    ds_read_b64_tr_b16 a[248:249], v63 offset:16384
    ds_read_b64_tr_b16 a[250:251], v63 offset:20480
    ds_read_b64_tr_b16 a[252:253], v63 offset:18432
    ds_read_b64_tr_b16 a[254:255], v63 offset:22528
Lwe_95:
    s_waitcnt lgkmcnt(0)
    s_barrier
    ds_read_b128 v[16:19], v4 offset:1536
    ds_read_b128 v[20:23], v4 offset:1600
    ds_read_b128 v[24:27], v4 offset:1664
    ds_read_b128 v[28:31], v4 offset:1728
    s_waitcnt lgkmcnt(3)
    v_mfma_f32_16x16x32_bf16 v[56:59], v[16:19], v[112:115], 0
    s_waitcnt lgkmcnt(2)
    v_mfma_f32_16x16x32_bf16 v[56:59], v[20:23], v[116:119], v[56:59]
    s_waitcnt lgkmcnt(1)
    v_mfma_f32_16x16x32_bf16 v[56:59], v[24:27], v[120:123], v[56:59]
    s_waitcnt lgkmcnt(0)
    v_mfma_f32_16x16x32_bf16 v[56:59], v[28:31], v[124:127], v[56:59]
    s_nop 7
    v_cndmask_b32 v32, v57, v56, s[46:47]
    v_bfi_b32 v32, s35, v32, v1
    s_cmp_eq_u32 s13, 0
    s_cbranch_scc1 Lpg_106
    s_mov_b32 exec_lo, 0xffffffff
    s_mov_b32 exec_hi, 0
    global_store_dword v14, v32, s[10:11]
    s_mov_b64 exec, -1
    s_branch Lpe_107
Lpg_106:
    s_mov_b32 exec_lo, 0xffffffff
    s_mov_b32 exec_hi, 0
    global_store_dword v14, v32, s[10:11] sc1
    s_mov_b64 exec, -1
Lpe_107:
    s_cmp_lg_u32 s3, 0
    s_cbranch_scc1 Lw1_108
    s_lshl_b32 s41, s4, 9
    s_add_u32 s41, s41, 274432
    v_and_b32 v12, 31, v0
    v_lshlrev_b32 v12, 4, v12
    v_add_u32 v12, s41, v12
    s_lshl_b32 s41, s4, 14
    s_lshl_b32 s44, s6, 12
    s_add_u32 s41, s41, s44
    s_add_u32 s41, s41, 1441792
    s_lshl_b32 s42, s7, 6
    s_add_u32 s41, s41, s42
    v_lshrrev_b32 v9, 3, v0
    v_lshlrev_b32 v9, 7, v9
    v_and_b32 v11, 7, v0
    v_lshl_add_u32 v9, v11, 3, v9
    v_add_u32 v9, s41, v9
    v_lshlrev_b32 v10, 3, v0
    v_add_u32 v10, 154368, v10
    ds_read_b64 v[48:49], v10
    v_lshlrev_b32 v11, 2, v0
    v_add_u32 v11, 153600, v11
    global_load_dwordx4 v[52:55], v12, s[10:11] sc1
    global_load_dwordx2 v[32:33], v9, s[10:11] offset:0 sc1
    global_load_dwordx2 v[34:35], v9, s[10:11] offset:1024 sc1
    global_load_dwordx2 v[36:37], v9, s[10:11] offset:2048 sc1
    global_load_dwordx2 v[38:39], v9, s[10:11] offset:3072 sc1
    s_waitcnt vmcnt(4)
    v_xor_b32 v52, s50, v52
    v_xor_b32 v53, s50, v53
    v_xor_b32 v54, s50, v54
    v_xor_b32 v55, s50, v55
    v_or3_b32 v15, v52, v53, v54
    v_or_b32 v15, v15, v55
    v_and_b32 v15, 0xff, v15
    v_cmp_eq_u32 vcc, 0, v15
    s_nop 0
    s_cmp_eq_u64 vcc, exec
    s_cbranch_scc1 Lok_110
    s_mov_b32 s38, 0
Lpoll_111:
    global_load_dwordx4 v[52:55], v12, s[10:11] sc1
    s_waitcnt vmcnt(0)
    v_xor_b32 v52, s50, v52
    v_xor_b32 v53, s50, v53
    v_xor_b32 v54, s50, v54
    v_xor_b32 v55, s50, v55
    v_or3_b32 v15, v52, v53, v54
    v_or_b32 v15, v15, v55
    v_and_b32 v15, 0xff, v15
    v_cmp_eq_u32 vcc, 0, v15
    s_nop 0
    s_cmp_eq_u64 vcc, exec
    s_cbranch_scc1 Lpdone_112
Lpretry_113:
    s_add_u32 s38, s38, 1
    s_cmp_lt_u32 s38, 65536
    s_cbranch_scc1 Lpoll_111
Lpdone_112:
Lok_110:
    s_cmp_eq_u32 s7, 0
    s_cbranch_scc1 Lb0_114
    v_mov_b32 v52, v54
    v_mov_b32 v53, v55
Lb0_114:
    s_nop 0
    v_add_f32_dpp v52, v52, v52 row_ror:8 row_mask:0xf bank_mask:0xf
    v_add_f32_dpp v53, v53, v53 row_ror:8 row_mask:0xf bank_mask:0xf
    s_nop 0
    v_add_f32_dpp v52, v52, v52 row_ror:4 row_mask:0xf bank_mask:0xf
    v_add_f32_dpp v53, v53, v53 row_ror:4 row_mask:0xf bank_mask:0xf
    s_nop 0
    v_add_f32_dpp v52, v52, v52 row_ror:2 row_mask:0xf bank_mask:0xf
    v_add_f32_dpp v53, v53, v53 row_ror:2 row_mask:0xf bank_mask:0xf
    s_nop 0
    v_add_f32_dpp v52, v52, v52 row_ror:1 row_mask:0xf bank_mask:0xf
    v_add_f32_dpp v53, v53, v53 row_ror:1 row_mask:0xf bank_mask:0xf
    v_mov_b32 v54, v52
    v_mov_b32 v55, v53
    s_nop 0
    v_permlane16_swap_b32 v52, v54
    v_permlane16_swap_b32 v53, v55
    v_add_f32 v52, v52, v54
    v_add_f32 v53, v53, v55
    v_mul_f32 v76, 0x3b000000, v52
    v_mul_f32 v53, 0x3b000000, v53
    v_fma_f32 v53, -v76, v76, v53
    v_max_f32 v53, 0, v53
    v_add_f32 v53, 0x3727c5ac, v53
    v_rsq_f32 v77, v53
    s_waitcnt vmcnt(0)
    v_xor_b32 v32, s50, v32
    v_xor_b32 v33, s50, v33
    v_xor_b32 v34, s50, v34
    v_xor_b32 v35, s50, v35
    v_xor_b32 v36, s50, v36
    v_xor_b32 v37, s50, v37
    v_xor_b32 v38, s50, v38
    v_xor_b32 v39, s50, v39
    v_or3_b32 v15, v32, v33, v34
    v_or3_b32 v15, v15, v35, v36
    v_or3_b32 v15, v15, v37, v38
    v_or_b32 v15, v15, v39
    v_and_b32 v15, 0xff, v15
    v_cmp_eq_u32 vcc, 0, v15
    s_nop 0
    s_cmp_eq_u64 vcc, exec
    s_cbranch_scc1 Lok_115
    s_mov_b32 s38, 0
Lpoll_116:
    global_load_dwordx2 v[32:33], v9, s[10:11] offset:0 sc1
    global_load_dwordx2 v[34:35], v9, s[10:11] offset:1024 sc1
    global_load_dwordx2 v[36:37], v9, s[10:11] offset:2048 sc1
    global_load_dwordx2 v[38:39], v9, s[10:11] offset:3072 sc1
    s_waitcnt vmcnt(0)
    v_xor_b32 v32, s50, v32
    v_xor_b32 v33, s50, v33
    v_xor_b32 v34, s50, v34
    v_xor_b32 v35, s50, v35
    v_xor_b32 v36, s50, v36
    v_xor_b32 v37, s50, v37
    v_xor_b32 v38, s50, v38
    v_xor_b32 v39, s50, v39
    v_or3_b32 v15, v32, v33, v34
    v_or3_b32 v15, v15, v35, v36
    v_or3_b32 v15, v15, v37, v38
    v_or_b32 v15, v15, v39
    v_and_b32 v15, 0xff, v15
    v_cmp_eq_u32 vcc, 0, v15
    s_nop 0
    s_cmp_eq_u64 vcc, exec
    s_cbranch_scc1 Lpdone_117
Lpretry_118:
    s_add_u32 s38, s38, 1
    s_cmp_lt_u32 s38, 65536
    s_cbranch_scc1 Lpoll_116
Lpdone_117:
Lok_115:
    v_add_f32 v32, v32, v34
    v_add_f32 v36, v36, v38
    v_add_f32 v33, v33, v35
    v_add_f32 v37, v37, v39
    v_add_f32 v32, v32, v36
    v_add_f32 v33, v33, v37
    s_waitcnt lgkmcnt(0)
    v_fma_f32 v32, -v76, v48, v32
    v_fma_f32 v33, -v76, v49, v33
    v_mul_f32 v32, v77, v32
    v_mul_f32 v33, v77, v33
    v_cvt_pk_bf16_f32 v32, v32, v33
    ds_write_b32 v11, v32
Lw1_108:
    s_waitcnt lgkmcnt(0)
    s_barrier
    ds_read_b128 v[16:19], v5 offset:0
    ds_read_b128 v[20:23], v5 offset:64
    ds_read_b128 v[24:27], v5 offset:128
    ds_read_b128 v[28:31], v5 offset:192
    s_waitcnt lgkmcnt(0)
    s_waitcnt lgkmcnt(0)
    v_mfma_f32_16x16x32_bf16 v[32:35], v[128:131], v[16:19], 0
    v_mfma_f32_16x16x32_bf16 v[32:35], v[132:135], v[20:23], v[32:35]
    v_mfma_f32_16x16x32_bf16 v[32:35], v[136:139], v[24:27], v[32:35]
    v_mfma_f32_16x16x32_bf16 v[32:35], v[140:143], v[28:31], v[32:35]
    v_mov_b64 v[64:65], 0
    v_mfma_f32_16x16x32_bf16 v[36:39], v[144:147], v[16:19], 0
    v_mfma_f32_16x16x32_bf16 v[36:39], v[148:151], v[20:23], v[36:39]
    v_mfma_f32_16x16x32_bf16 v[36:39], v[152:155], v[24:27], v[36:39]
    v_mfma_f32_16x16x32_bf16 v[36:39], v[156:159], v[28:31], v[36:39]
    v_mov_b64 v[68:69], 0
    v_mfma_f32_16x16x32_bf16 v[40:43], v[160:163], v[16:19], 0
    v_mfma_f32_16x16x32_bf16 v[40:43], v[164:167], v[20:23], v[40:43]
    v_mfma_f32_16x16x32_bf16 v[40:43], v[168:171], v[24:27], v[40:43]
    v_mfma_f32_16x16x32_bf16 v[40:43], v[172:175], v[28:31], v[40:43]
    v_cndmask_b32 v32, v32, v34, s[56:57]
    v_cndmask_b32 v33, v33, v35, s[56:57]
    v_max_f32 v9, v32, v33
    v_mov_b64 v[72:73], 0
    v_mfma_f32_16x16x32_bf16 v[44:47], v[176:179], v[16:19], 0
    v_mfma_f32_16x16x32_bf16 v[44:47], v[180:183], v[20:23], v[44:47]
    v_mfma_f32_16x16x32_bf16 v[44:47], v[184:187], v[24:27], v[44:47]
    v_mfma_f32_16x16x32_bf16 v[44:47], v[188:191], v[28:31], v[44:47]
    v_cndmask_b32 v34, v36, v38, s[56:57]
    v_cndmask_b32 v35, v37, v39, s[56:57]
    v_max3_f32 v9, v9, v34, v35
    v_mov_b64 v[76:77], 0
    v_mfma_f32_16x16x32_bf16 v[48:51], v[192:195], v[16:19], 0
    v_mfma_f32_16x16x32_bf16 v[48:51], v[196:199], v[20:23], v[48:51]
    v_mfma_f32_16x16x32_bf16 v[48:51], v[200:203], v[24:27], v[48:51]
    v_mfma_f32_16x16x32_bf16 v[48:51], v[204:207], v[28:31], v[48:51]
    v_cndmask_b32 v36, v40, v42, s[56:57]
    v_cndmask_b32 v37, v41, v43, s[56:57]
    v_max3_f32 v9, v9, v36, v37
    v_mfma_f32_16x16x32_bf16 v[52:55], v[208:211], v[16:19], 0
    v_mfma_f32_16x16x32_bf16 v[52:55], v[212:215], v[20:23], v[52:55]
    v_mfma_f32_16x16x32_bf16 v[52:55], v[216:219], v[24:27], v[52:55]
    v_mfma_f32_16x16x32_bf16 v[52:55], v[220:223], v[28:31], v[52:55]
    v_cndmask_b32 v38, v44, v46, s[56:57]
    v_cndmask_b32 v39, v45, v47, s[56:57]
    v_max3_f32 v9, v9, v38, v39
    v_mfma_f32_16x16x32_bf16 v[56:59], v[224:227], v[16:19], 0
    v_mfma_f32_16x16x32_bf16 v[56:59], v[228:231], v[20:23], v[56:59]
    v_mfma_f32_16x16x32_bf16 v[56:59], v[232:235], v[24:27], v[56:59]
    v_mfma_f32_16x16x32_bf16 v[56:59], v[236:239], v[28:31], v[56:59]
    v_cndmask_b32 v40, v48, v50, s[56:57]
    v_cndmask_b32 v41, v49, v51, s[56:57]
    v_max3_f32 v9, v9, v40, v41
    v_mfma_f32_16x16x32_bf16 v[60:63], v[240:243], v[16:19], 0
    v_mfma_f32_16x16x32_bf16 v[60:63], v[244:247], v[20:23], v[60:63]
    v_mfma_f32_16x16x32_bf16 v[60:63], v[248:251], v[24:27], v[60:63]
    v_mfma_f32_16x16x32_bf16 v[60:63], v[252:255], v[28:31], v[60:63]
    v_cndmask_b32 v42, v52, v54, s[56:57]
    v_cndmask_b32 v43, v53, v55, s[56:57]
    v_max3_f32 v9, v9, v42, v43
    v_mov_b32 v14, 0x44444444
    v_mov_b32 v15, 0xeeeeeeee
    v_cndmask_b32 v14, v14, v15, s[56:57]
    v_cndmask_b32 v44, v56, v58, s[56:57]
    v_cndmask_b32 v45, v57, v59, s[56:57]
    v_max3_f32 v9, v9, v44, v45
    v_cndmask_b32 v46, v60, v62, s[56:57]
    v_cndmask_b32 v47, v61, v63, s[56:57]
    v_max3_f32 v9, v9, v46, v47
    s_nop 1
    v_max_f32_dpp v9, v9, v9 quad_perm:[1,0,3,2] row_mask:0xf bank_mask:0xf
    v_mov_b32 v10, v9
    s_nop 1
    v_permlane16_swap_b32 v9, v10
    v_max_f32 v9, v9, v10
    v_mov_b32 v10, v9
    s_nop 1
    v_permlane32_swap_b32 v9, v10
    v_max_f32 v9, v9, v10
    v_mul_f32 v12, s34, v9
    v_mov_b64 v[16:17], 0
    v_mov_b64 v[20:21], 0
    v_mov_b64 v[24:25], 0
    v_mov_b64 v[28:29], 0
    v_fma_f32 v32, v32, s34, -v12
    v_fma_f32 v33, v33, s34, -v12
    v_fma_f32 v34, v34, s34, -v12
    v_fma_f32 v35, v35, s34, -v12
    v_fma_f32 v36, v36, s34, -v12
    v_fma_f32 v37, v37, s34, -v12
    v_fma_f32 v38, v38, s34, -v12
    v_fma_f32 v39, v39, s34, -v12
    v_exp_f32 v32, v32
    v_exp_f32 v33, v33
    v_exp_f32 v34, v34
    v_exp_f32 v35, v35
    v_exp_f32 v36, v36
    v_exp_f32 v37, v37
    v_exp_f32 v38, v38
    v_exp_f32 v39, v39
    v_cvt_pk_bf16_f32 v48, v32, v33
    v_cvt_pk_bf16_f32 v49, v34, v35
    v_cvt_pk_bf16_f32 v50, v36, v37
    v_cvt_pk_bf16_f32 v51, v38, v39
    s_nop 1
    v_smfmac_f32_16x16x64_bf16 v[64:67], v[48:51], a[128:135], v14
    v_fma_f32 v40, v40, s34, -v12
    v_fma_f32 v41, v41, s34, -v12
    v_smfmac_f32_16x16x64_bf16 v[68:71], v[48:51], a[144:151], v14
    v_fma_f32 v42, v42, s34, -v12
    v_fma_f32 v43, v43, s34, -v12
    v_fma_f32 v44, v44, s34, -v12
    v_smfmac_f32_16x16x64_bf16 v[72:75], v[48:51], a[160:167], v14
    v_fma_f32 v45, v45, s34, -v12
    v_fma_f32 v46, v46, s34, -v12
    v_smfmac_f32_16x16x64_bf16 v[76:79], v[48:51], a[176:183], v14
    v_fma_f32 v47, v47, s34, -v12
    v_exp_f32 v40, v40
    v_exp_f32 v41, v41
    v_smfmac_f32_16x16x64_bf16 v[16:19], v[48:51], a[192:199], v14
    v_exp_f32 v42, v42
    v_exp_f32 v43, v43
    v_smfmac_f32_16x16x64_bf16 v[20:23], v[48:51], a[208:215], v14
    v_exp_f32 v44, v44
    v_exp_f32 v45, v45
    v_exp_f32 v46, v46
    v_smfmac_f32_16x16x64_bf16 v[24:27], v[48:51], a[224:231], v14
    v_exp_f32 v47, v47
    v_cvt_pk_bf16_f32 v52, v40, v41
    v_smfmac_f32_16x16x64_bf16 v[28:31], v[48:51], a[240:247], v14
    v_cvt_pk_bf16_f32 v53, v42, v43
    v_cvt_pk_bf16_f32 v54, v44, v45
    v_cvt_pk_bf16_f32 v55, v46, v47
    s_nop 1
    v_smfmac_f32_16x16x64_bf16 v[64:67], v[52:55], a[136:143], v14
    v_add_f32 v13, v32, v33
    v_add_f32 v15, v40, v41
    v_smfmac_f32_16x16x64_bf16 v[68:71], v[52:55], a[152:159], v14
    v_add_f32 v13, v13, v34
    v_add_f32 v15, v15, v42
    v_add_f32 v13, v13, v35
    v_smfmac_f32_16x16x64_bf16 v[72:75], v[52:55], a[168:175], v14
    v_add_f32 v15, v15, v43
    v_add_f32 v13, v13, v36
    v_add_f32 v15, v15, v44
    v_smfmac_f32_16x16x64_bf16 v[76:79], v[52:55], a[184:191], v14
    v_add_f32 v13, v13, v37
    v_add_f32 v15, v15, v45
    v_add_f32 v13, v13, v38
    v_smfmac_f32_16x16x64_bf16 v[16:19], v[52:55], a[200:207], v14
    v_add_f32 v15, v15, v46
    v_add_f32 v13, v13, v39
    v_smfmac_f32_16x16x64_bf16 v[20:23], v[52:55], a[216:223], v14
    v_add_f32 v15, v15, v47
    v_add_f32 v13, v13, v15
    s_nop 1
    v_add_f32_dpp v13, v13, v13 quad_perm:[1,0,3,2] row_mask:0xf bank_mask:0xf
    v_smfmac_f32_16x16x64_bf16 v[24:27], v[52:55], a[232:239], v14
    v_mov_b32 v10, v13
    s_nop 1
    v_permlane16_swap_b32 v13, v10
    v_add_f32 v13, v13, v10
    v_smfmac_f32_16x16x64_bf16 v[28:31], v[52:55], a[248:255], v14
    v_mov_b32 v10, v13
    s_nop 1
    v_permlane32_swap_b32 v13, v10
    v_add_f32 v13, v13, v10
    v_and_b32 v9, 15, v0
    v_lshlrev_b32 v9, 2, v9
    s_lshl_b32 s41, s3, 9
    s_add_u32 s41, s41, 147456
    v_add_u32 v9, s41, v9
    s_lshl_b32 s41, s3, 3
    s_add_u32 s41, s41, 149504
    v_mov_b32 v10, s41
    s_mov_b32 exec_lo, 0xffff
    s_mov_b32 exec_hi, 0
    v_add_f32 v64, v64, v65
    v_add_f32 v68, v68, v69
    ds_write2_b32 v9, v64, v68 offset0:0 offset1:16
    v_add_f32 v72, v72, v73
    v_add_f32 v76, v76, v77
    ds_write2_b32 v9, v72, v76 offset0:32 offset1:48
    v_add_f32 v16, v16, v17
    v_add_f32 v20, v20, v21
    ds_write2_b32 v9, v16, v20 offset0:64 offset1:80
    v_add_f32 v24, v24, v25
    v_add_f32 v28, v28, v29
    ds_write2_b32 v9, v24, v28 offset0:96 offset1:112
    s_mov_b64 exec, 1
    ds_write_b64 v10, v[12:13]
    s_mov_b64 exec, -1
    s_waitcnt lgkmcnt(0)
    s_barrier
    s_cmp_lg_u32 s3, 0
    s_cbranch_scc1 Lw1_119
    v_lshlrev_b32 v9, 3, v0
    v_add_u32 v10, 147456, v9
    v_mov_b32 v11, 149504
    ds_read_b128 v[48:51], v11
    ds_read_b128 v[52:55], v11 offset:16
    ds_read_b64 v[32:33], v10 offset:0
    ds_read_b64 v[34:35], v10 offset:512
    ds_read_b64 v[36:37], v10 offset:1024
    ds_read_b64 v[38:39], v10 offset:1536
    s_lshl_b32 s41, s4, 15
    s_lshl_b32 s42, s5, 10
    s_add_u32 s41, s41, s42
    s_add_u32 s41, s41, 2883584
    v_add_u32 v9, s41, v9
    v_mov_b32 v10, s41
    s_waitcnt lgkmcnt(4)
    v_max3_f32 v56, v48, v50, v52
    v_mov_b32 v58, v1
    v_max_f32 v56, v56, v54
    v_mov_b32 v59, v1
    v_sub_f32 v48, v48, v56
    v_sub_f32 v50, v50, v56
    v_sub_f32 v52, v52, v56
    v_sub_f32 v54, v54, v56
    v_exp_f32 v48, v48
    v_exp_f32 v50, v50
    v_exp_f32 v52, v52
    v_exp_f32 v54, v54
    s_waitcnt lgkmcnt(0)
    v_mul_f32 v32, v48, v32
    v_mul_f32 v33, v48, v33
    v_mul_f32 v57, v48, v49
    v_fmac_f32 v32, v50, v34
    v_fmac_f32 v33, v50, v35
    v_fmac_f32 v57, v50, v51
    v_fmac_f32 v32, v52, v36
    v_fmac_f32 v33, v52, v37
    v_fmac_f32 v57, v52, v53
    v_fmac_f32 v32, v54, v38
    v_fmac_f32 v33, v54, v39
    v_fmac_f32 v57, v54, v55
    v_bfi_b32 v32, s35, v32, v1
    v_bfi_b32 v33, s35, v33, v1
    s_cmp_eq_u32 s13, 0
    s_cbranch_scc1 Lpg_121
    global_store_dwordx2 v9, v[32:33], s[10:11]
    s_mov_b64 exec, 1
    global_store_dwordx4 v10, v[56:59], s[10:11] offset:512
    s_mov_b64 exec, -1
    s_branch Lpe_122
Lpg_121:
    global_store_dwordx2 v9, v[32:33], s[10:11] sc1
    s_mov_b64 exec, 1
    global_store_dwordx4 v10, v[56:59], s[10:11] offset:512 sc1
    s_mov_b64 exec, -1
Lpe_122:
    s_lshr_b32 s41, s5, 2
    s_lshl_b32 s41, s41, 2
    s_add_u32 s41, s41, s3
    s_lshl_b32 s41, s41, 12
    s_lshl_b32 s42, s4, 2
    s_add_u32 s42, s42, s9
    s_lshl_b32 s42, s42, 7
    s_add_u32 s41, s41, s42
    s_add_u32 s41, s41, 917504
    v_and_b32 v14, 31, v0
    v_lshlrev_b32 v14, 2, v14
    v_add_u32 v14, s41, v14
    v_lshrrev_b32 v9, 5, v0
    v_lshlrev_b32 v9, 12, v9
    s_lshl_b32 s41, s4, 15
    s_lshl_b32 s42, s9, 13
    s_add_u32 s41, s41, s42
    s_add_u32 s41, s41, 2883584
    v_add_u32 v9, s41, v9
    v_and_b32 v10, 3, v0
    v_lshl_add_u32 v10, v10, 10, v9
    v_and_b32 v11, 31, v0
    v_lshl_add_u32 v9, v11, 4, v9
    v_lshlrev_b32 v11, 3, v11
    v_lshrrev_b32 v15, 5, v0
    v_mul_u32_u24 v15, 320, v15
    v_add_u32 v11, v11, v15
    v_add_u32 v11, 150528, v11
    s_mov_b32 s38, 0
Lpoll_123:
    global_load_dwordx4 v[32:35], v9, s[10:11] offset:0 sc1
    global_load_dwordx4 v[36:39], v9, s[10:11] offset:1024 sc1
    global_load_dwordx4 v[40:43], v9, s[10:11] offset:2048 sc1
    global_load_dwordx4 v[44:47], v9, s[10:11] offset:3072 sc1
    global_load_dwordx4 v[48:51], v10, s[10:11] offset:512 sc1
    s_waitcnt vmcnt(0)
    v_xor_b32 v32, s50, v32
    v_xor_b32 v33, s50, v33
    v_xor_b32 v34, s50, v34
    v_xor_b32 v35, s50, v35
    v_xor_b32 v36, s50, v36
    v_xor_b32 v37, s50, v37
    v_xor_b32 v38, s50, v38
    v_xor_b32 v39, s50, v39
    v_xor_b32 v40, s50, v40
    v_xor_b32 v41, s50, v41
    v_xor_b32 v42, s50, v42
    v_xor_b32 v43, s50, v43
    v_xor_b32 v44, s50, v44
    v_xor_b32 v45, s50, v45
    v_xor_b32 v46, s50, v46
    v_xor_b32 v47, s50, v47
    v_or3_b32 v15, v32, v33, v34
    v_or3_b32 v15, v15, v35, v36
    v_or3_b32 v15, v15, v37, v38
    v_or3_b32 v15, v15, v39, v40
    v_or3_b32 v15, v15, v41, v42
    v_or3_b32 v15, v15, v43, v44
    v_or3_b32 v15, v15, v45, v46
    v_or_b32 v15, v15, v47
    v_and_b32 v15, 0xff, v15
    v_bitop3_b32 v15, v50, v15, v1 bitop3:0xDE
    v_bitop3_b32 v15, v51, v15, v1 bitop3:0xDE
    v_cmp_eq_u32 vcc, 0, v15
    s_nop 0
    s_cmp_eq_u64 vcc, exec
    s_cbranch_scc1 Lpdone_124
Lpretry_125:
    s_add_u32 s38, s38, 1
    s_cmp_lt_u32 s38, 65536
    s_cbranch_scc1 Lpoll_123
Lpdone_124:
    v_max_f32_dpp v9, v48, v48 quad_perm:[1,0,3,2] row_mask:0xf bank_mask:0xf
    s_nop 1
    v_max_f32_dpp v9, v9, v9 quad_perm:[2,3,0,1] row_mask:0xf bank_mask:0xf
    v_sub_f32 v48, v48, v9
    v_exp_f32 v48, v48
    s_nop 0
    v_mul_f32 v49, v48, v49
    s_nop 1
    v_add_f32_dpp v9, v49, v49 quad_perm:[1,0,3,2] row_mask:0xf bank_mask:0xf
    s_nop 1
    v_add_f32_dpp v9, v9, v9 quad_perm:[2,3,0,1] row_mask:0xf bank_mask:0xf
    v_rcp_f32 v9, v9
    s_nop 0
    v_mul_f32 v48, v48, v9
    s_nop 1
    v_mul_f32_dpp v52, v48, v32 quad_perm:[0,0,0,0] row_mask:0xf bank_mask:0xf
    v_mul_f32_dpp v53, v48, v33 quad_perm:[0,0,0,0] row_mask:0xf bank_mask:0xf
    v_mul_f32_dpp v54, v48, v34 quad_perm:[0,0,0,0] row_mask:0xf bank_mask:0xf
    v_mul_f32_dpp v55, v48, v35 quad_perm:[0,0,0,0] row_mask:0xf bank_mask:0xf
    v_fmac_f32_dpp v52, v48, v36 quad_perm:[1,1,1,1] row_mask:0xf bank_mask:0xf
    v_fmac_f32_dpp v53, v48, v37 quad_perm:[1,1,1,1] row_mask:0xf bank_mask:0xf
    v_fmac_f32_dpp v54, v48, v38 quad_perm:[1,1,1,1] row_mask:0xf bank_mask:0xf
    v_fmac_f32_dpp v55, v48, v39 quad_perm:[1,1,1,1] row_mask:0xf bank_mask:0xf
    v_fmac_f32_dpp v52, v48, v40 quad_perm:[2,2,2,2] row_mask:0xf bank_mask:0xf
    v_fmac_f32_dpp v53, v48, v41 quad_perm:[2,2,2,2] row_mask:0xf bank_mask:0xf
    v_fmac_f32_dpp v54, v48, v42 quad_perm:[2,2,2,2] row_mask:0xf bank_mask:0xf
    v_fmac_f32_dpp v55, v48, v43 quad_perm:[2,2,2,2] row_mask:0xf bank_mask:0xf
    v_fmac_f32_dpp v52, v48, v44 quad_perm:[3,3,3,3] row_mask:0xf bank_mask:0xf
    v_fmac_f32_dpp v53, v48, v45 quad_perm:[3,3,3,3] row_mask:0xf bank_mask:0xf
    v_fmac_f32_dpp v54, v48, v46 quad_perm:[3,3,3,3] row_mask:0xf bank_mask:0xf
    v_fmac_f32_dpp v55, v48, v47 quad_perm:[3,3,3,3] row_mask:0xf bank_mask:0xf
    v_cvt_pk_bf16_f32 v52, v52, v53
    v_cvt_pk_bf16_f32 v53, v54, v55
    ds_write_b64 v11, v[52:53]
    s_branch Lwe_120
Lw1_119:
    s_lshr_b32 s41, s5, 2
    s_lshl_b32 s41, s41, 2
    s_add_u32 s41, s41, s3
    s_lshl_b32 s41, s41, 12
    s_lshl_b32 s42, s4, 2
    s_add_u32 s42, s42, s9
    s_lshl_b32 s42, s42, 7
    s_add_u32 s41, s41, s42
    s_add_u32 s41, s41, 917504
    v_and_b32 v14, 31, v0
    v_lshlrev_b32 v14, 2, v14
    v_add_u32 v14, s41, v14
Lwe_120:
    s_waitcnt lgkmcnt(0)
    s_barrier
    ds_read_b128 v[16:19], v4 offset:0
    ds_read_b128 v[20:23], v4 offset:64
    ds_read_b128 v[24:27], v4 offset:128
    ds_read_b128 v[28:31], v4 offset:192
    s_waitcnt lgkmcnt(3)
    v_mfma_f32_16x16x32_bf16 v[56:59], v[16:19], v[80:83], 0
    s_waitcnt lgkmcnt(2)
    v_mfma_f32_16x16x32_bf16 v[56:59], v[20:23], v[84:87], v[56:59]
    s_waitcnt lgkmcnt(1)
    v_mfma_f32_16x16x32_bf16 v[56:59], v[24:27], v[88:91], v[56:59]
    s_waitcnt lgkmcnt(0)
    v_mfma_f32_16x16x32_bf16 v[56:59], v[28:31], v[92:95], v[56:59]
    s_nop 7
    v_cndmask_b32 v32, v57, v56, s[46:47]
    v_bfi_b32 v32, s35, v32, v1
    s_mov_b32 exec_lo, 0xffffffff
    s_mov_b32 exec_hi, 0
    global_store_dword v14, v32, s[10:11] sc1
    s_mov_b64 exec, -1
    s_cmp_lg_u32 s4, 0
    s_cbranch_scc1 Lfin_126
    s_cmp_lg_u32 s3, 0
    s_cbranch_scc1 Lfin_126
    s_lshl_b32 s41, s5, 12
    s_add_u32 s41, s41, 917504
    v_lshlrev_b32 v13, 4, v0
    v_add_u32 v13, s41, v13
    v_and_b32 v9, 7, v0
    v_lshrrev_b32 v10, 4, v0
    v_lshl_add_u32 v9, v9, 2, v10
    v_lshrrev_b32 v10, 4, v9
    v_and_b32 v9, 15, v9
    v_lshlrev_b32 v10, 9, v10
    v_add_u32 v9, v9, v10
    s_lshl_b32 s41, s5, 4
    v_add_u32 v9, s41, v9
    v_lshlrev_b32 v9, 1, v9
    s_mov_b32 s38, 0
    s_sleep 11
Lpoll_127:
    global_load_dwordx4 v[32:35], v13, s[10:11] offset:0 sc1
    global_load_dwordx4 v[36:39], v13, s[10:11] offset:1024 sc1
    global_load_dwordx4 v[40:43], v13, s[10:11] offset:2048 sc1
    global_load_dwordx4 v[44:47], v13, s[10:11] offset:3072 sc1
    s_waitcnt vmcnt(0)
    v_xor_b32 v32, s50, v32
    v_xor_b32 v33, s50, v33
    v_xor_b32 v34, s50, v34
    v_xor_b32 v35, s50, v35
    v_xor_b32 v36, s50, v36
    v_xor_b32 v37, s50, v37
    v_xor_b32 v38, s50, v38
    v_xor_b32 v39, s50, v39
    v_xor_b32 v40, s50, v40
    v_xor_b32 v41, s50, v41
    v_xor_b32 v42, s50, v42
    v_xor_b32 v43, s50, v43
    v_xor_b32 v44, s50, v44
    v_xor_b32 v45, s50, v45
    v_xor_b32 v46, s50, v46
    v_xor_b32 v47, s50, v47
    v_or3_b32 v15, v32, v33, v34
    v_or3_b32 v15, v15, v35, v36
    v_or3_b32 v15, v15, v37, v38
    v_or3_b32 v15, v15, v39, v40
    v_or3_b32 v15, v15, v41, v42
    v_or3_b32 v15, v15, v43, v44
    v_or3_b32 v15, v15, v45, v46
    v_or_b32 v15, v15, v47
    v_and_b32 v15, 0xff, v15
    v_cmp_eq_u32 vcc, 0, v15
    s_nop 0
    s_cmp_eq_u64 vcc, exec
    s_cbranch_scc1 Lpdone_128
Lpretry_129:
    s_add_u32 s38, s38, 1
    s_cmp_lt_u32 s38, 65536
    s_cbranch_scc1 Lpoll_127
Lpdone_128:
    v_add_f32 v32, v32, v36
    v_add_f32 v40, v40, v44
    v_add_f32 v33, v33, v37
    v_add_f32 v41, v41, v45
    v_add_f32 v34, v34, v38
    v_add_f32 v42, v42, v46
    v_add_f32 v35, v35, v39
    v_add_f32 v43, v43, v47
    v_add_f32 v32, v32, v40
    v_add_f32 v33, v33, v41
    v_add_f32 v34, v34, v42
    v_add_f32 v35, v35, v43
    v_add_f32_dpp v32, v32, v32 row_ror:8 row_mask:0xf bank_mask:0xf
    v_add_f32_dpp v33, v33, v33 row_ror:8 row_mask:0xf bank_mask:0xf
    v_add_f32_dpp v34, v34, v34 row_ror:8 row_mask:0xf bank_mask:0xf
    v_add_f32_dpp v35, v35, v35 row_ror:8 row_mask:0xf bank_mask:0xf
    v_permlane16_swap_b32 v32, v33
    s_nop 0
    v_permlane16_swap_b32 v34, v35
    v_add_f32 v32, v32, v33
    v_add_f32 v34, v34, v35
    s_nop 1
    v_permlane32_swap_b32 v32, v34
    v_add_f32 v32, v32, v34
    v_cvt_pk_bf16_f32 v32, v32, v32
    v_and_b32 v32, 0xffff0000, v32
    v_add_f32 v32, v3, v32
    v_cvt_pk_bf16_f32 v32, v32, v32
    v_and_b32 v3, 0xffff0000, v32
    s_mov_b32 exec_lo, 0xff00ff
    s_mov_b32 exec_hi, 0xff00ff
    global_store_short_d16_hi v9, v3, s[14:15]
    s_mov_b64 exec, 1
    s_cmp_lg_u32 s5, 0
    s_cbranch_scc1 Lep_130
    v_mov_b32 v9, 0
    global_store_dword v9, v1, s[10:11]
Lep_130:
    s_mov_b64 exec, -1
Lfin_126:
    s_waitcnt vmcnt(0)
L_end:

s_endpgm
.section .rodata,"a"
.p2align 6
.amdhsa_kernel interleave_layers__sliding_block_cached__sliding_block_cached__decode_kernel
  .amdhsa_next_free_vgpr 512
  .amdhsa_next_free_sgpr 100
  .amdhsa_accum_offset 256
  .amdhsa_group_segment_fixed_size 0
  .amdhsa_kernarg_size 104
  .amdhsa_user_sgpr_count 2
  .amdhsa_user_sgpr_kernarg_segment_ptr 1
  .amdhsa_system_sgpr_workgroup_id_x 1
  .amdhsa_float_denorm_mode_32 3
  .amdhsa_float_denorm_mode_16_64 3
.end_amdhsa_kernel
```
